```python
import torch

def _softmax(x, axis=-1):
    return torch.softmax(x, dim=axis)
def _gelu(x):
    return torch.nn.functional.gelu(x, approximate="tanh")
def _silu(x):
    return torch.nn.functional.silu(x)
def _sigmoid(x):
    return torch.sigmoid(x)
def _layernorm(x, axis=-1, eps=1e-5):
    m = x.mean(dim=axis, keepdim=True)
    v = x.var(dim=axis, keepdim=True, unbiased=False)
    return (x - m) / torch.sqrt(v + eps)
def _scatter_add(tgt, idx, src, axis=0):
    return tgt.clone().index_add_(axis, idx, src)
def _segment_sum(src, seg, n):
    out = torch.zeros((n,) + src.shape[1:], dtype=src.dtype)
    return out.index_add_(0, seg, src)
def _pad(x, pw):
    flat = tuple(v for pair in reversed(pw) for v in pair)
    return torch.nn.functional.pad(x, flat)

kernel_name = 'concat_heads__compressed_kv_cla__sliding_block_cached__decode'

def setup_inputs():

    _w = (lambda a: (lambda t: t.to(torch.bfloat16) if t.is_floating_point() else t)(torch.as_tensor(a)))
    def _A_setup():
        B, H, Sq, Sk, D, M = 2, 32, 1, 8192, 128, 512
        Dc = 4 * D
        return {
            "x": _w((lambda *s: torch.randn(*s, dtype=torch.bfloat16) * 3.2)(B, Sq, M)),
            "c_kv": _w((lambda *s: torch.randn(*s, dtype=torch.bfloat16) * 0.1)(B, Sk, Dc)),
            "w_q": _w((lambda *s: torch.randn(*s, dtype=torch.bfloat16) * 6.4)(M, H, D) * (M ** -0.5)),
            "w_uk": _w((lambda *s: torch.randn(*s, dtype=torch.bfloat16) * 6.4)(Dc, H, D) * (Dc ** -0.5)),
            "w_uv": _w((lambda *s: torch.randn(*s, dtype=torch.bfloat16) * 0.1)(Dc, H, D) * (Dc ** -0.5)),
            "w_o": _w((lambda *s: torch.randn(*s, dtype=torch.bfloat16) * 0.1)(H, D, M) * ((H * D) ** -0.5)),
        }
    _A_in = _A_setup()

    def _B_setup():
        B, Sq, D = 2, 1, 512
        Hq, Hkv, Sk, Dh = 32, 8, 8192, 128
        assert Hq % Hkv == 0, (Hq, Hkv)
        return {
            "x": _w((lambda *s: torch.randn(*s, dtype=torch.bfloat16) * 1.6)(B, Sq, D)),
            "k_cache": _w((lambda *s: torch.randn(*s, dtype=torch.bfloat16) * 1.6)(B, Hkv, Sk, Dh)),
            "v_cache": _w((lambda *s: torch.randn(*s, dtype=torch.bfloat16) * 0.05)(B, Hkv, Sk, Dh)),
            "wq": _w((lambda *s: torch.randn(*s, dtype=torch.bfloat16) * 1.6)(D, Hq * Dh) * (D ** -0.5)),
            "wo": _w((lambda *s: torch.randn(*s, dtype=torch.bfloat16) * 0.05)(Hq * Dh, D) * ((Hq * Dh) ** -0.5)),
        }
    _B_in = _B_setup()

    return {
        "A_x": _A_in["x"],
        "A_c_kv": _A_in["c_kv"],
        "A_w_q": _A_in["w_q"],
        "A_w_uk": _A_in["w_uk"],
        "A_w_uv": _A_in["w_uv"],
        "A_w_o": _A_in["w_o"],
        "B_x": _B_in["x"],
        "B_k_cache": _B_in["k_cache"],
        "B_v_cache": _B_in["v_cache"],
        "B_wq": _B_in["wq"],
        "B_wo": _B_in["wo"],
    }

def reference(A_x, A_c_kv, A_w_q, A_w_uk, A_w_uv, A_w_o, B_x, B_k_cache, B_v_cache, B_wq, B_wo):
    def _A_ref(x, c_kv, w_q, w_uk, w_uv, w_o):
        B, Sq, M = x.shape[0], x.shape[1], x.shape[2]
        Sk = c_kv.shape[1]
        H, D = w_q.shape[1], w_q.shape[2]
        q = torch.einsum("bqm,mhd->bhqd", x, w_q)
        k = torch.einsum("bkc,chd->bhkd", c_kv, w_uk)
        v = torch.einsum("bkc,chd->bhkd", c_kv, w_uv)
        scores = torch.einsum("bhqd,bhkd->bhqk", q, k) * (D ** -0.5)
        off = Sk - Sq
        qi = torch.arange(Sq)[:, None]
        kj = torch.arange(Sk)[None, :]
        cmask = kj <= (qi + off)
        scores = torch.where(cmask[None, None], scores, -1e9)
        p = _softmax(scores, axis=-1)
        ctx = torch.einsum("bhqk,bhkd->bhqd", p, v)
        return torch.einsum("bhqd,hdm->bqm", ctx, w_o)

    def _B_ref(x, k_cache, v_cache, wq, wo):
        B, Sq, D = x.shape
        Hq, Dh = 32, 128
        Hkv, Sk = k_cache.shape[1], k_cache.shape[2]
        W = min(4096, max(256, Sk // 4))
        rep = Hq // Hkv
        q = (lambda x, *d: x.permute(*d))((x @ wq).reshape(B, Sq, Hq, Dh), 0, 2, 1, 3)
        k = (lambda x, n, axis: torch.repeat_interleave(x, n, dim=axis))(k_cache[:, :, Sk - W:, :], rep, axis=1)
        v = (lambda x, n, axis: torch.repeat_interleave(x, n, dim=axis))(v_cache[:, :, Sk - W:, :], rep, axis=1)
        scores = torch.einsum("bhqd,bhkd->bhqk", q, k) * (Dh ** -0.5)
        p = _softmax(scores, axis=-1)
        o = torch.einsum("bhqk,bhkd->bhqd", p, v)
        return (lambda x, *d: x.permute(*d))(o, 0, 2, 1, 3).reshape(B, Sq, Hq * Dh) @ wo

    a = _A_ref(A_x, A_c_kv, A_w_q, A_w_uk, A_w_uv, A_w_o)
    b = _B_ref(B_x, B_k_cache, B_v_cache, B_wq, B_wo)
    return torch.concatenate([a, b], axis=-1)
```

```asm
; @launch grid=(256,1,1) block=(512,1,1) lds=163840
.amdgcn_target "amdgcn-amd-amdhsa--gfx950"
.text
.globl concat_heads__compressed_kv_cla__sliding_block_cached__decode_kernel
.p2align 8
.type concat_heads__compressed_kv_cla__sliding_block_cached__decode_kernel,@function
concat_heads__compressed_kv_cla__sliding_block_cached__decode_kernel:
  s_getpc_b64 s[4:5]
  s_cmp_ge_u32 s2, 256
  s_cbranch_scc1 L_end
  s_load_dwordx16 s[16:31], s[0:1], 0
  s_load_dwordx8 s[32:39], s[0:1], 64
  s_load_dwordx4 s[40:43], s[0:1], 96
  v_lshrrev_b32 v1, 6, v0
  s_nop 0
  v_readfirstlane_b32 s3, v1
  v_and_b32 v0, 63, v0
  v_lshrrev_b32 v1, 4, v0
  v_and_b32 v2, 15, v0
  v_bfe_u32 v3, v0, 2, 2
  v_and_b32 v4, 3, v0
  s_mov_b64 s[92:93], 0xffff
  s_mov_b32 s94, -1
  s_mov_b32 s95, 0
  s_cmp_ge_u32 s3, 4
  s_cbranch_scc1 L_help
  s_cmp_ge_u32 s2, 128
  s_cbranch_scc1 L_AA
L_AB:
  s_setprio 2
  s_and_b32 s84, s2, 7
  s_bfe_u32 s85, s2, 0x40003
  s_lshr_b32 s98, s85, 2
  s_lshl_b32 s98, s98, 3
  s_add_u32 s98, s98, s84
  s_and_b32 s99, s85, 3
  s_lshl_b32 s100, s98, 2
  s_add_u32 s100, s100, s99
  s_and_b32 s84, s2, 7
  s_bfe_u32 s85, s2, 0x40003
  s_lshr_b32 s101, s85, 3
  s_lshl_b32 s101, s101, 3
  s_add_u32 s101, s101, s84
  s_lshl_b32 s101, s101, 3
  s_and_b32 s85, s85, 7
  s_add_u32 s101, s101, s85
  v_lshlrev_b32 v5, 1, v1
  v_xor_b32 v6, v5, v2
  v_lshlrev_b32 v6, 4, v6
  v_mul_u32_u24 v5, 8192, v1
  v_add_u32 v8, v5, v6
  v_xor_b32 v9, 0x80, v8
  s_lshl_b32 s76, s99, 20
  s_lshl_b32 s77, s98, 8
  s_add_u32 s76, s76, s77
  s_lshl_b32 s77, s3, 18
  s_add_u32 s76, s76, s77
  s_lshl_b32 s77, s3, 13
  s_add_u32 s78, s77, 98304
  s_add_u32 s77, s77, 65536
  v_and_b32 v5, 1, v0
  v_lshlrev_b32 v5, 10, v5
  v_lshl_add_u32 v14, v1, 4, v5
  s_lshl_b32 s80, s99, 8
  v_add_u32 v14, s80, v14
  s_waitcnt lgkmcnt(0)
  s_mov_b32 s44, s20
  s_and_b32 s45, s21, 0xffff
  s_mov_b32 s46, 0x400000
  s_mov_b32 s47, 0x20000
  s_add_u32 m0, s77, 0
  s_add_u32 s88, s76, 0
  buffer_load_dwordx4 v8, s[44:47], s88 offen nt lds
  s_add_u32 m0, s77, 1024
  s_add_u32 s88, s76, 32768
  buffer_load_dwordx4 v8, s[44:47], s88 offen nt lds
  s_add_u32 m0, s77, 2048
  s_add_u32 s88, s76, 65536
  buffer_load_dwordx4 v9, s[44:47], s88 offen nt lds
  s_add_u32 m0, s77, 3072
  s_add_u32 s88, s76, 98304
  buffer_load_dwordx4 v9, s[44:47], s88 offen nt lds
  s_add_u32 m0, s77, 4096
  s_add_u32 s88, s76, 131072
  buffer_load_dwordx4 v8, s[44:47], s88 offen nt lds
  s_add_u32 m0, s77, 5120
  s_add_u32 s88, s76, 163840
  buffer_load_dwordx4 v8, s[44:47], s88 offen nt lds
  s_add_u32 m0, s77, 6144
  s_add_u32 s88, s76, 196608
  buffer_load_dwordx4 v9, s[44:47], s88 offen nt lds
  s_add_u32 m0, s77, 7168
  s_add_u32 s88, s76, 229376
  buffer_load_dwordx4 v9, s[44:47], s88 offen nt lds
  global_load_dwordx4 v[16:19], v14, s[16:17] offset:0
  global_load_dwordx4 v[20:23], v14, s[16:17] offset:64
  global_load_dwordx4 v[24:27], v14, s[16:17] offset:128
  global_load_dwordx4 v[28:31], v14, s[16:17] offset:192
  s_load_dword s74, s[42:43], 0x0
  s_barrier
L_AB_2:
  v_xor_b32 v6, v1, v2
  v_lshlrev_b32 v6, 4, v6
  v_mul_u32_u24 v5, 8192, v1
  v_add_u32 v10, v5, v6
  v_xor_b32 v11, 0x40, v10
  v_xor_b32 v12, 0x80, v10
  v_xor_b32 v13, 0xc0, v10
  v_lshlrev_b32 v15, 4, v0
  s_mov_b32 s68, s42
  s_and_b32 s69, s43, 0xffff
  s_mov_b32 s70, 0x10000000
  s_mov_b32 s71, 0x20000
  v_and_b32 v5, 1, v1
  v_lshl_or_b32 v5, v5, 2, v3
  v_lshlrev_b32 v5, 1, v5
  v_lshrrev_b32 v6, 1, v4
  v_xor_b32 v6, v6, v5
  v_lshlrev_b32 v6, 4, v6
  v_lshl_add_u32 v5, v1, 3, v3
  v_lshl_add_u32 v6, v5, 8, v6
  v_and_b32 v5, 1, v4
  v_lshl_add_u32 v76, v5, 3, v6
  v_add_u32 v76, 0x10000, v76
  s_lshl_b32 s89, s3, 6
  v_xor_b32 v76, s89, v76
  v_xor_b32 v77, 32, v76
  s_waitcnt lgkmcnt(0)
  s_mul_i32 s72, s74, 1664525
  s_add_u32 s72, s72, 1013904223
  s_xor_b32 s73, s72, 0x5bd1e995
  s_mov_b32 s48, s22
  s_and_b32 s49, s23, 0xffff
  s_mov_b32 s50, 0x400000
  s_mov_b32 s51, 0x20000
  s_waitcnt vmcnt(11)
  s_add_u32 m0, s78, 0
  s_add_u32 s88, s76, 0
  buffer_load_dwordx4 v10, s[48:51], s88 offen nt lds
  s_waitcnt vmcnt(11)
  s_add_u32 m0, s78, 1024
  s_add_u32 s88, s76, 32768
  buffer_load_dwordx4 v11, s[48:51], s88 offen nt lds
  s_waitcnt vmcnt(11)
  s_add_u32 m0, s78, 2048
  s_add_u32 s88, s76, 65536
  buffer_load_dwordx4 v12, s[48:51], s88 offen nt lds
  s_waitcnt vmcnt(11)
  s_add_u32 m0, s78, 3072
  s_add_u32 s88, s76, 98304
  buffer_load_dwordx4 v13, s[48:51], s88 offen nt lds
  s_waitcnt vmcnt(11)
  s_add_u32 m0, s78, 4096
  s_add_u32 s88, s76, 131072
  buffer_load_dwordx4 v10, s[48:51], s88 offen nt lds
  s_waitcnt vmcnt(11)
  s_add_u32 m0, s78, 5120
  s_add_u32 s88, s76, 163840
  buffer_load_dwordx4 v11, s[48:51], s88 offen nt lds
  s_waitcnt vmcnt(11)
  s_add_u32 m0, s78, 6144
  s_add_u32 s88, s76, 196608
  buffer_load_dwordx4 v12, s[48:51], s88 offen nt lds
  s_waitcnt vmcnt(11)
  s_add_u32 m0, s78, 7168
  s_add_u32 s88, s76, 229376
  buffer_load_dwordx4 v13, s[48:51], s88 offen nt lds
  s_waitcnt vmcnt(8)
  s_waitcnt lgkmcnt(0)
  s_barrier
  ds_read_b64_tr_b16 v[32:33], v76 offset:0
  ds_read_b64_tr_b16 v[34:35], v76 offset:1024
  ds_read_b64_tr_b16 v[36:37], v77 offset:0
  ds_read_b64_tr_b16 v[38:39], v77 offset:1024
  ds_read_b64_tr_b16 v[40:41], v76 offset:8192
  ds_read_b64_tr_b16 v[42:43], v76 offset:9216
  ds_read_b64_tr_b16 v[44:45], v77 offset:8192
  ds_read_b64_tr_b16 v[46:47], v77 offset:9216
  ds_read_b64_tr_b16 v[48:49], v76 offset:16384
  ds_read_b64_tr_b16 v[50:51], v76 offset:17408
  ds_read_b64_tr_b16 v[52:53], v77 offset:16384
  ds_read_b64_tr_b16 v[54:55], v77 offset:17408
  s_waitcnt lgkmcnt(8)
  v_mfma_f32_16x16x32_bf16 v[64:67], v[16:19], v[32:35], 0
  v_mfma_f32_16x16x32_bf16 v[68:71], v[16:19], v[36:39], 0
  ds_read_b64_tr_b16 v[56:57], v76 offset:24576
  ds_read_b64_tr_b16 v[58:59], v76 offset:25600
  ds_read_b64_tr_b16 v[60:61], v77 offset:24576
  ds_read_b64_tr_b16 v[62:63], v77 offset:25600
  s_waitcnt lgkmcnt(8)
  v_mfma_f32_16x16x32_bf16 v[64:67], v[20:23], v[40:43], v[64:67]
  v_mfma_f32_16x16x32_bf16 v[68:71], v[20:23], v[44:47], v[68:71]
  s_waitcnt lgkmcnt(4)
  v_mfma_f32_16x16x32_bf16 v[64:67], v[24:27], v[48:51], v[64:67]
  v_mfma_f32_16x16x32_bf16 v[68:71], v[24:27], v[52:55], v[68:71]
  s_waitcnt lgkmcnt(0)
  v_mfma_f32_16x16x32_bf16 v[64:67], v[28:31], v[56:59], v[64:67]
  v_mfma_f32_16x16x32_bf16 v[68:71], v[28:31], v[60:63], v[68:71]
  s_nop 8
  s_lshl_b32 s82, s100, 11
  s_lshl_b32 s81, s3, 9
  s_add_u32 s82, s82, s81
  s_add_u32 s82, s82, 0x10000
  v_cndmask_b32 v72, v68, v64, s[92:93]
  v_cndmask_b32 v73, v69, v65, s[92:93]
  v_mov_b32 v74, s72
  v_mov_b32 v75, s73
  s_mov_b64 exec, s[94:95]
  buffer_store_dwordx4 v[72:75], v15, s[68:71], s82 offen
  s_mov_b64 exec, -1
  s_lshl_b32 s80, s98, 13
  s_add_u32 s80, s80, 0x10000
  v_lshrrev_b32 v88, 5, v0
  v_and_b32 v89, 31, v0
  v_lshlrev_b32 v90, 4, v89
  v_lshl_add_u32 v88, v88, 11, v90
  s_lshl_b32 s86, s3, 9
  s_add_u32 s86, s86, s80
  s_add_u32 s87, s86, 4096
  s_mov_b32 s75, 0
L_poll_q_1:
  buffer_load_dwordx4 v[80:83], v88, s[68:71], s86 offen offset:0 sc1
  buffer_load_dwordx4 v[84:87], v88, s[68:71], s87 offen offset:0 sc1
  s_waitcnt vmcnt(0)
  v_cmp_eq_u64 vcc, s[72:73], v[82:83]
  v_cmp_eq_u64 s[96:97], s[72:73], v[86:87]
  s_and_b64 vcc, vcc, s[96:97]
  s_cmp_eq_u64 vcc, exec
  s_cbranch_scc1 L_pdone_q_2
  s_add_u32 s75, s75, 1
  s_cmp_lt_u32 s75, 64
  s_cbranch_scc1 L_poll_q_1
  s_cmp_lg_u32 s75, 64
  s_cbranch_scc1 L_pfb_3
  s_mov_b64 exec, s[94:95]
  s_xor_b32 s89, s82, 0x2000000
  buffer_store_dwordx4 v[72:75], v15, s[68:71], s89 offen sc1
  s_mov_b64 exec, -1
L_pfb_3:
  s_xor_b32 s86, s86, 0x2000000
  s_xor_b32 s87, s87, 0x2000000
  s_cmp_lt_u32 s75, 400000
  s_cbranch_scc1 L_poll_q_1
L_pdone_q_2:
  s_mov_b64 exec, s[94:95]
  s_xor_b32 s89, s82, 0x2000000
  buffer_store_dwordx4 v[72:75], v15, s[68:71], s89 offen sc1
  s_mov_b64 exec, -1
  v_add_f32 v80, v80, v84
  v_add_f32 v81, v81, v85
  v_mov_b32 v82, v80
  v_mov_b32 v83, v81
  s_nop 0
  v_permlane32_swap_b32 v80, v82
  v_permlane32_swap_b32 v81, v83
  s_nop 0
  v_add_f32 v80, v80, v82
  v_add_f32 v81, v81, v83
  v_cvt_pk_bf16_f32 v80, v80, v81
  s_lshl_b32 s86, s3, 6
  s_add_u32 s86, s86, 0x10000
  v_lshl_add_u32 v88, v89, 1, s86
  ds_write_b16 v88, v80
  ds_write_b16_d16_hi v88, v80 offset:256
  s_waitcnt lgkmcnt(0)
  s_barrier
  v_and_b32 v5, 1, v0
  v_mul_u32_u24 v5, 256, v5
  v_lshl_add_u32 v5, v1, 4, v5
  v_add_u32 v5, 0x10000, v5
  ds_read_b128 v[16:19], v5 offset:0
  ds_read_b128 v[20:23], v5 offset:64
  ds_read_b128 v[24:27], v5 offset:128
  ds_read_b128 v[28:31], v5 offset:192
  v_xor_b32 v5, v1, v2
  v_lshlrev_b32 v5, 4, v5
  v_lshl_add_u32 v5, v2, 8, v5
  s_lshl_b32 s80, s3, 13
  s_add_u32 s80, s80, 98304
  v_add_u32 v76, s80, v5
  v_xor_b32 v77, 0x40, v76
  v_xor_b32 v78, 0x80, v76
  v_xor_b32 v79, 0xc0, v76
  ds_read_b128 v[32:35], v76 offset:0
  ds_read_b128 v[48:51], v76 offset:4096
  ds_read_b128 v[36:39], v77 offset:0
  ds_read_b128 v[52:55], v77 offset:4096
  ds_read_b128 v[40:43], v78 offset:0
  ds_read_b128 v[56:59], v78 offset:4096
  ds_read_b128 v[44:47], v79 offset:0
  ds_read_b128 v[60:63], v79 offset:4096
  s_waitcnt lgkmcnt(6)
  v_mfma_f32_16x16x32_bf16 v[64:67], v[16:19], v[32:35], 0
  v_mfma_f32_16x16x32_bf16 v[68:71], v[16:19], v[48:51], 0
  s_waitcnt lgkmcnt(4)
  v_mfma_f32_16x16x32_bf16 v[64:67], v[20:23], v[36:39], v[64:67]
  v_mfma_f32_16x16x32_bf16 v[68:71], v[20:23], v[52:55], v[68:71]
  s_waitcnt lgkmcnt(2)
  v_mfma_f32_16x16x32_bf16 v[64:67], v[24:27], v[40:43], v[64:67]
  v_mfma_f32_16x16x32_bf16 v[68:71], v[24:27], v[56:59], v[68:71]
  s_waitcnt lgkmcnt(0)
  v_mfma_f32_16x16x32_bf16 v[64:67], v[28:31], v[44:47], v[64:67]
  v_mfma_f32_16x16x32_bf16 v[68:71], v[28:31], v[60:63], v[68:71]
  s_lshl_b32 s80, s3, 7
  s_add_u32 s80, s80, 66560
  v_lshl_add_u32 v5, v2, 1, s80
  v_lshl_add_u32 v6, v0, 4, s80
  v_lshrrev_b32 v7, 2, v0
  v_lshlrev_b32 v7, 15, v7
  v_lshl_add_u32 v7, v4, 4, v7
  s_lshl_b32 s80, s98, 10
  s_lshl_b32 s81, s99, 8
  s_add_u32 s80, s80, s81
  s_lshl_b32 s81, s3, 6
  s_add_u32 s80, s80, s81
  s_add_u32 s80, s80, 0x50000
  v_cvt_pk_bf16_f32 v72, v64, v65
  v_cvt_pk_bf16_f32 v73, v68, v69
  ds_write_b16 v5, v72
  ds_write_b16_d16_hi v5, v72 offset:64
  ds_write_b16 v5, v73 offset:32
  ds_write_b16_d16_hi v5, v73 offset:96
  s_waitcnt lgkmcnt(0)
  s_mov_b64 exec, 0xff
  ds_read_b128 v[72:75], v6
  s_waitcnt lgkmcnt(0)
  buffer_store_dwordx4 v[72:75], v7, s[68:71], s80 offen sc1
  s_mov_b64 exec, -1
  s_waitcnt vmcnt(0)
  s_waitcnt lgkmcnt(0)
  s_barrier
  s_cmp_lg_u32 s3, 0
  s_cbranch_scc1 L_AB_noflag
  v_mov_b32 v72, 0
  v_mov_b32 v73, 0
  v_mov_b32 v74, s72
  v_mov_b32 v75, s73
  v_lshrrev_b32 v5, 2, v0
  v_mul_u32_u24 v5, 8448, v5
  v_lshl_add_u32 v5, v4, 4, v5
  s_lshl_b32 s80, s100, 6
  s_add_u32 s80, s80, 0x300000
  s_mov_b64 exec, 0xffffffff
  buffer_store_dwordx4 v[72:75], v5, s[68:71], s80 offen sc1
  s_mov_b64 exec, -1
L_AB_noflag:
  s_and_b32 s84, s2, 7
  s_bfe_u32 s85, s2, 0x40003
  s_lshr_b32 s98, s85, 2
  s_lshl_b32 s84, s84, 2
  s_add_u32 s98, s98, s84
  s_and_b32 s99, s85, 3
  v_lshlrev_b32 v5, 1, v1
  v_xor_b32 v6, v5, v2
  v_lshlrev_b32 v6, 4, v6
  v_mul_u32_u24 v5, 8192, v1
  v_add_u32 v8, v5, v6
  v_xor_b32 v9, 0x80, v8
  s_lshl_b32 s76, s99, 20
  s_lshl_b32 s77, s98, 8
  s_add_u32 s76, s76, s77
  s_lshl_b32 s77, s3, 18
  s_add_u32 s76, s76, s77
  s_lshl_b32 s77, s3, 13
  s_add_u32 s77, s77, 32768
  s_mov_b32 s44, s34
  s_and_b32 s45, s35, 0xffff
  s_mov_b32 s46, 0x400000
  s_mov_b32 s47, 0x20000
  s_add_u32 m0, s77, 0
  s_add_u32 s88, s76, 0
  buffer_load_dwordx4 v8, s[44:47], s88 offen nt lds
  s_add_u32 m0, s77, 1024
  s_add_u32 s88, s76, 32768
  buffer_load_dwordx4 v8, s[44:47], s88 offen nt lds
  s_add_u32 m0, s77, 2048
  s_add_u32 s88, s76, 65536
  buffer_load_dwordx4 v9, s[44:47], s88 offen nt lds
  s_add_u32 m0, s77, 3072
  s_add_u32 s88, s76, 98304
  buffer_load_dwordx4 v9, s[44:47], s88 offen nt lds
  s_add_u32 m0, s77, 4096
  s_add_u32 s88, s76, 131072
  buffer_load_dwordx4 v8, s[44:47], s88 offen nt lds
  s_add_u32 m0, s77, 5120
  s_add_u32 s88, s76, 163840
  buffer_load_dwordx4 v8, s[44:47], s88 offen nt lds
  s_add_u32 m0, s77, 6144
  s_add_u32 s88, s76, 196608
  buffer_load_dwordx4 v9, s[44:47], s88 offen nt lds
  s_add_u32 m0, s77, 7168
  s_add_u32 s88, s76, 229376
  buffer_load_dwordx4 v9, s[44:47], s88 offen nt lds
  global_load_dwordx4 v[16:19], v14, s[28:29] offset:0
  global_load_dwordx4 v[20:23], v14, s[28:29] offset:64
  global_load_dwordx4 v[24:27], v14, s[28:29] offset:128
  global_load_dwordx4 v[28:31], v14, s[28:29] offset:192
  v_and_b32 v5, 1, v1
  v_lshl_or_b32 v5, v5, 2, v3
  v_lshlrev_b32 v5, 1, v5
  v_lshrrev_b32 v6, 1, v4
  v_xor_b32 v6, v6, v5
  v_lshlrev_b32 v6, 4, v6
  v_lshl_add_u32 v5, v1, 3, v3
  v_lshl_add_u32 v6, v5, 8, v6
  v_and_b32 v5, 1, v4
  v_lshl_add_u32 v76, v5, 3, v6
  v_add_u32 v76, 0x8000, v76
  s_lshl_b32 s89, s3, 6
  v_xor_b32 v76, s89, v76
  v_xor_b32 v77, 32, v76
  v_and_b32 v5, 1, v1
  v_lshlrev_b32 v5, 12, v5
  v_lshl_add_u32 v6, v2, 4, v5
  s_lshl_b32 s100, s98, 13
  s_lshl_b32 s81, s99, 10
  s_add_u32 s100, s100, s81
  s_lshl_b32 s81, s3, 8
  s_add_u32 s100, s100, s81
  s_add_u32 s100, s100, 0x70000
  s_waitcnt vmcnt(0)
  s_barrier
  ds_read_b64_tr_b16 v[32:33], v76 offset:0
  ds_read_b64_tr_b16 v[34:35], v76 offset:1024
  ds_read_b64_tr_b16 v[36:37], v77 offset:0
  ds_read_b64_tr_b16 v[38:39], v77 offset:1024
  ds_read_b64_tr_b16 v[40:41], v76 offset:8192
  ds_read_b64_tr_b16 v[42:43], v76 offset:9216
  ds_read_b64_tr_b16 v[44:45], v77 offset:8192
  ds_read_b64_tr_b16 v[46:47], v77 offset:9216
  ds_read_b64_tr_b16 v[48:49], v76 offset:16384
  ds_read_b64_tr_b16 v[50:51], v76 offset:17408
  ds_read_b64_tr_b16 v[52:53], v77 offset:16384
  ds_read_b64_tr_b16 v[54:55], v77 offset:17408
  s_waitcnt lgkmcnt(8)
  v_mfma_f32_16x16x32_bf16 v[64:67], v[16:19], v[32:35], 0
  v_mfma_f32_16x16x32_bf16 v[68:71], v[16:19], v[36:39], 0
  ds_read_b64_tr_b16 v[56:57], v76 offset:24576
  ds_read_b64_tr_b16 v[58:59], v76 offset:25600
  ds_read_b64_tr_b16 v[60:61], v77 offset:24576
  ds_read_b64_tr_b16 v[62:63], v77 offset:25600
  s_waitcnt lgkmcnt(8)
  v_mfma_f32_16x16x32_bf16 v[64:67], v[20:23], v[40:43], v[64:67]
  v_mfma_f32_16x16x32_bf16 v[68:71], v[20:23], v[44:47], v[68:71]
  s_waitcnt lgkmcnt(4)
  v_mfma_f32_16x16x32_bf16 v[64:67], v[24:27], v[48:51], v[64:67]
  v_mfma_f32_16x16x32_bf16 v[68:71], v[24:27], v[52:55], v[68:71]
  s_waitcnt lgkmcnt(0)
  v_mfma_f32_16x16x32_bf16 v[64:67], v[28:31], v[56:59], v[64:67]
  v_mfma_f32_16x16x32_bf16 v[68:71], v[28:31], v[60:63], v[68:71]
  s_nop 8
  s_barrier
  v_cndmask_b32 v228, v65, v64, s[92:93]
  v_cndmask_b32 v229, v69, v68, s[92:93]
  v_mov_b32 v230, s72
  v_mov_b32 v231, s73
  s_mov_b64 exec, s[94:95]
  buffer_store_dwordx4 v[228:231], v6, s[68:71], s100 offen
  s_mov_b64 exec, -1
  s_and_b32 s80, s2, 7
  s_lshl_b32 s80, s80, 2
  s_add_u32 s80, s80, s3
  s_lshl_b32 s80, s80, 13
  s_bfe_u32 s81, s2, 0x10006
  s_lshl_b32 s81, s81, 12
  s_add_u32 s80, s80, s81
  s_add_u32 s80, s80, 0x70000
  s_mov_b32 s75, 0
L_poll_qb_4:
  buffer_load_dwordx4 v[32:35], v15, s[68:71], s80 offen offset:0 sc1
  buffer_load_dwordx4 v[36:39], v15, s[68:71], s80 offen offset:1024 sc1
  buffer_load_dwordx4 v[40:43], v15, s[68:71], s80 offen offset:2048 sc1
  buffer_load_dwordx4 v[44:47], v15, s[68:71], s80 offen offset:3072 sc1
  s_waitcnt vmcnt(0)
  v_cmp_eq_u64 vcc, s[72:73], v[34:35]
  v_cmp_eq_u64 s[96:97], s[72:73], v[38:39]
  s_and_b64 vcc, vcc, s[96:97]
  v_cmp_eq_u64 s[96:97], s[72:73], v[42:43]
  s_and_b64 vcc, vcc, s[96:97]
  v_cmp_eq_u64 s[96:97], s[72:73], v[46:47]
  s_and_b64 vcc, vcc, s[96:97]
  s_cmp_eq_u64 vcc, exec
  s_cbranch_scc1 L_pdone_qb_5
  s_add_u32 s75, s75, 1
  s_cmp_lt_u32 s75, 64
  s_cbranch_scc1 L_poll_qb_4
  s_cmp_lg_u32 s75, 64
  s_cbranch_scc1 L_pfb_6
  s_mov_b64 exec, s[94:95]
  s_xor_b32 s89, s100, 0x2000000
  buffer_store_dwordx4 v[228:231], v6, s[68:71], s89 offen sc1
  s_mov_b64 exec, -1
L_pfb_6:
  s_xor_b32 s80, s80, 0x2000000
  s_cmp_lt_u32 s75, 400000
  s_cbranch_scc1 L_poll_qb_4
L_pdone_qb_5:
  s_mov_b64 exec, s[94:95]
  s_xor_b32 s89, s100, 0x2000000
  buffer_store_dwordx4 v[228:231], v6, s[68:71], s89 offen sc1
  s_mov_b64 exec, -1
  v_add_f32 v32, v32, v36
  v_add_f32 v40, v40, v44
  v_add_f32 v32, v32, v40
  v_add_f32 v33, v33, v37
  v_add_f32 v41, v41, v45
  v_add_f32 v33, v33, v41
  v_cvt_pk_bf16_f32 v32, v32, v33
  v_lshlrev_b32 v5, 6, v1
  v_lshl_add_u32 v5, v2, 1, v5
  s_lshl_b32 s81, s3, 8
  s_add_u32 s81, s81, 131072
  v_add_u32 v5, s81, v5
  ds_write_b16 v5, v32
  ds_write_b16_d16_hi v5, v32 offset:32
  s_lshl_b32 s77, s3, 14
  s_add_u32 s78, s77, 65536
  v_xor_b32 v5, v1, v2
  v_lshlrev_b32 v5, 4, v5
  v_lshl_add_u32 v5, v2, 8, v5
  v_add_u32 v76, s77, v5
  v_xor_b32 v77, 0x40, v76
  v_xor_b32 v78, 0x80, v76
  v_xor_b32 v79, 0xc0, v76
  s_waitcnt lgkmcnt(0)
  s_barrier
  v_and_b32 v5, 3, v0
  v_mul_u32_u24 v5, 256, v5
  v_lshl_add_u32 v5, v1, 4, v5
  v_add_u32 v5, 0x20000, v5
  ds_read_b128 v[16:19], v5 offset:0
  ds_read_b128 v[20:23], v5 offset:64
  ds_read_b128 v[24:27], v5 offset:128
  ds_read_b128 v[28:31], v5 offset:192
  ds_read_b128 v[96:99], v76 offset:0
  ds_read_b128 v[100:103], v77 offset:0
  ds_read_b128 v[104:107], v78 offset:0
  ds_read_b128 v[108:111], v79 offset:0
  ds_read_b128 v[112:115], v76 offset:4096
  ds_read_b128 v[116:119], v77 offset:4096
  ds_read_b128 v[120:123], v78 offset:4096
  ds_read_b128 v[124:127], v79 offset:4096
  s_waitcnt lgkmcnt(4)
  v_mfma_f32_16x16x32_bf16 v[32:35], v[96:99], v[16:19], 0
  v_mfma_f32_16x16x32_bf16 v[32:35], v[100:103], v[20:23], v[32:35]
  v_mfma_f32_16x16x32_bf16 v[32:35], v[104:107], v[24:27], v[32:35]
  v_mfma_f32_16x16x32_bf16 v[32:35], v[108:111], v[28:31], v[32:35]
  ds_read_b128 v[128:131], v76 offset:8192
  ds_read_b128 v[132:135], v77 offset:8192
  ds_read_b128 v[136:139], v78 offset:8192
  ds_read_b128 v[140:143], v79 offset:8192
  s_waitcnt lgkmcnt(4)
  v_mfma_f32_16x16x32_bf16 v[36:39], v[112:115], v[16:19], 0
  v_mfma_f32_16x16x32_bf16 v[36:39], v[116:119], v[20:23], v[36:39]
  v_mfma_f32_16x16x32_bf16 v[36:39], v[120:123], v[24:27], v[36:39]
  v_mfma_f32_16x16x32_bf16 v[36:39], v[124:127], v[28:31], v[36:39]
  ds_read_b128 v[144:147], v76 offset:12288
  ds_read_b128 v[148:151], v77 offset:12288
  ds_read_b128 v[152:155], v78 offset:12288
  ds_read_b128 v[156:159], v79 offset:12288
  s_waitcnt lgkmcnt(4)
  v_mfma_f32_16x16x32_bf16 v[40:43], v[128:131], v[16:19], 0
  v_mfma_f32_16x16x32_bf16 v[40:43], v[132:135], v[20:23], v[40:43]
  v_mfma_f32_16x16x32_bf16 v[40:43], v[136:139], v[24:27], v[40:43]
  v_mfma_f32_16x16x32_bf16 v[40:43], v[140:143], v[28:31], v[40:43]
  s_waitcnt lgkmcnt(0)
  v_mfma_f32_16x16x32_bf16 v[44:47], v[144:147], v[16:19], 0
  v_mfma_f32_16x16x32_bf16 v[44:47], v[148:151], v[20:23], v[44:47]
  v_mfma_f32_16x16x32_bf16 v[44:47], v[152:155], v[24:27], v[44:47]
  v_mfma_f32_16x16x32_bf16 v[44:47], v[156:159], v[28:31], v[44:47]
  s_barrier
  s_nop 5
  v_max3_f32 v5, v32, v33, v34
  v_max3_f32 v5, v5, v35, v36
  v_max3_f32 v5, v5, v37, v38
  v_max3_f32 v5, v5, v39, v40
  v_max3_f32 v5, v5, v41, v42
  v_max3_f32 v5, v5, v43, v44
  v_max3_f32 v5, v5, v45, v46
  v_max_f32 v5, v5, v47
  v_mov_b32 v6, v5
  s_nop 1
  v_permlane16_swap_b32 v5, v6
  s_nop 0
  v_max_f32 v5, v5, v6
  v_mov_b32 v6, v5
  s_nop 1
  v_permlane32_swap_b32 v5, v6
  s_nop 0
  v_max_f32 v5, v5, v6
  s_mov_b32 s82, 0x3e0293ee
  v_mul_f32 v5, s82, v5
  v_fma_f32 v32, v32, s82, -v5
  v_fma_f32 v33, v33, s82, -v5
  v_fma_f32 v34, v34, s82, -v5
  v_fma_f32 v35, v35, s82, -v5
  v_fma_f32 v36, v36, s82, -v5
  v_fma_f32 v37, v37, s82, -v5
  v_fma_f32 v38, v38, s82, -v5
  v_fma_f32 v39, v39, s82, -v5
  v_fma_f32 v40, v40, s82, -v5
  v_fma_f32 v41, v41, s82, -v5
  v_fma_f32 v42, v42, s82, -v5
  v_fma_f32 v43, v43, s82, -v5
  v_fma_f32 v44, v44, s82, -v5
  v_fma_f32 v45, v45, s82, -v5
  v_fma_f32 v46, v46, s82, -v5
  v_fma_f32 v47, v47, s82, -v5
  v_exp_f32 v32, v32
  v_exp_f32 v33, v33
  v_exp_f32 v34, v34
  v_exp_f32 v35, v35
  v_exp_f32 v36, v36
  v_exp_f32 v37, v37
  v_exp_f32 v38, v38
  v_exp_f32 v39, v39
  v_exp_f32 v40, v40
  v_exp_f32 v41, v41
  v_exp_f32 v42, v42
  v_exp_f32 v43, v43
  v_exp_f32 v44, v44
  v_exp_f32 v45, v45
  v_exp_f32 v46, v46
  v_exp_f32 v47, v47
  s_nop 0
  v_add_f32 v6, v32, v33
  v_add_f32 v6, v6, v34
  v_add_f32 v6, v6, v35
  v_add_f32 v6, v6, v36
  v_add_f32 v6, v6, v37
  v_add_f32 v6, v6, v38
  v_add_f32 v6, v6, v39
  v_add_f32 v6, v6, v40
  v_add_f32 v6, v6, v41
  v_add_f32 v6, v6, v42
  v_add_f32 v6, v6, v43
  v_add_f32 v6, v6, v44
  v_add_f32 v6, v6, v45
  v_add_f32 v6, v6, v46
  v_add_f32 v6, v6, v47
  v_mov_b32 v7, v6
  s_nop 1
  v_permlane16_swap_b32 v6, v7
  s_nop 0
  v_add_f32 v6, v6, v7
  v_mov_b32 v7, v6
  s_nop 1
  v_permlane32_swap_b32 v6, v7
  s_nop 0
  v_add_f32 v6, v6, v7
  v_cvt_pk_bf16_f32 v48, v32, v33
  v_cvt_pk_bf16_f32 v49, v34, v35
  v_cvt_pk_bf16_f32 v50, v36, v37
  v_cvt_pk_bf16_f32 v51, v38, v39
  v_cvt_pk_bf16_f32 v52, v40, v41
  v_cvt_pk_bf16_f32 v53, v42, v43
  v_cvt_pk_bf16_f32 v54, v44, v45
  v_cvt_pk_bf16_f32 v55, v46, v47
  s_lshl_b32 s81, s3, 5
  s_add_u32 s81, s81, 141312
  v_lshl_add_u32 v7, v4, 3, s81
  v_mov_b32 v56, v5
  v_mov_b32 v57, v6
  ds_write_b64 v7, v[56:57]
  v_and_b32 v5, 1, v1
  v_lshl_or_b32 v5, v5, 2, v3
  v_lshlrev_b32 v5, 1, v5
  v_lshrrev_b32 v6, 1, v4
  v_or_b32 v5, v5, v6
  v_lshlrev_b32 v5, 4, v5
  v_lshl_add_u32 v6, v1, 2, v3
  v_lshl_add_u32 v5, v6, 8, v5
  v_and_b32 v6, 1, v4
  v_lshl_add_u32 v5, v6, 3, v5
  v_add_u32 v76, s78, v5
  v_xor_b32 v77, 0x20, v76
  v_xor_b32 v78, 0x40, v76
  v_xor_b32 v79, 0x60, v76
  v_xor_b32 v80, 0x80, v76
  v_xor_b32 v81, 0xa0, v76
  v_xor_b32 v82, 0xc0, v76
  v_xor_b32 v83, 0xe0, v76
  s_barrier
  ds_read_b64_tr_b16 v[96:97], v76 offset:0
  ds_read_b64_tr_b16 v[98:99], v76 offset:4096
  ds_read_b64_tr_b16 v[100:101], v76 offset:8192
  ds_read_b64_tr_b16 v[102:103], v76 offset:12288
  ds_read_b64_tr_b16 v[104:105], v77 offset:0
  ds_read_b64_tr_b16 v[106:107], v77 offset:4096
  ds_read_b64_tr_b16 v[108:109], v77 offset:8192
  ds_read_b64_tr_b16 v[110:111], v77 offset:12288
  ds_read_b64_tr_b16 v[112:113], v78 offset:0
  ds_read_b64_tr_b16 v[114:115], v78 offset:4096
  ds_read_b64_tr_b16 v[116:117], v78 offset:8192
  ds_read_b64_tr_b16 v[118:119], v78 offset:12288
  s_waitcnt lgkmcnt(8)
  v_mfma_f32_16x16x32_bf16 v[160:163], v[48:51], v[96:99], 0
  v_mfma_f32_16x16x32_bf16 v[160:163], v[52:55], v[100:103], v[160:163]
  ds_read_b64_tr_b16 v[120:121], v79 offset:0
  ds_read_b64_tr_b16 v[122:123], v79 offset:4096
  ds_read_b64_tr_b16 v[124:125], v79 offset:8192
  ds_read_b64_tr_b16 v[126:127], v79 offset:12288
  s_waitcnt lgkmcnt(8)
  v_mfma_f32_16x16x32_bf16 v[164:167], v[48:51], v[104:107], 0
  v_mfma_f32_16x16x32_bf16 v[164:167], v[52:55], v[108:111], v[164:167]
  ds_read_b64_tr_b16 v[128:129], v80 offset:0
  ds_read_b64_tr_b16 v[130:131], v80 offset:4096
  ds_read_b64_tr_b16 v[132:133], v80 offset:8192
  ds_read_b64_tr_b16 v[134:135], v80 offset:12288
  s_waitcnt lgkmcnt(8)
  v_mfma_f32_16x16x32_bf16 v[168:171], v[48:51], v[112:115], 0
  v_mfma_f32_16x16x32_bf16 v[168:171], v[52:55], v[116:119], v[168:171]
  ds_read_b64_tr_b16 v[136:137], v81 offset:0
  ds_read_b64_tr_b16 v[138:139], v81 offset:4096
  ds_read_b64_tr_b16 v[140:141], v81 offset:8192
  ds_read_b64_tr_b16 v[142:143], v81 offset:12288
  s_waitcnt lgkmcnt(8)
  v_mfma_f32_16x16x32_bf16 v[172:175], v[48:51], v[120:123], 0
  v_mfma_f32_16x16x32_bf16 v[172:175], v[52:55], v[124:127], v[172:175]
  ds_read_b64_tr_b16 v[144:145], v82 offset:0
  ds_read_b64_tr_b16 v[146:147], v82 offset:4096
  ds_read_b64_tr_b16 v[148:149], v82 offset:8192
  ds_read_b64_tr_b16 v[150:151], v82 offset:12288
  s_waitcnt lgkmcnt(8)
  v_mfma_f32_16x16x32_bf16 v[176:179], v[48:51], v[128:131], 0
  v_mfma_f32_16x16x32_bf16 v[176:179], v[52:55], v[132:135], v[176:179]
  ds_read_b64_tr_b16 v[152:153], v83 offset:0
  ds_read_b64_tr_b16 v[154:155], v83 offset:4096
  ds_read_b64_tr_b16 v[156:157], v83 offset:8192
  ds_read_b64_tr_b16 v[158:159], v83 offset:12288
  s_waitcnt lgkmcnt(8)
  v_mfma_f32_16x16x32_bf16 v[180:183], v[48:51], v[136:139], 0
  v_mfma_f32_16x16x32_bf16 v[180:183], v[52:55], v[140:143], v[180:183]
  s_waitcnt lgkmcnt(4)
  v_mfma_f32_16x16x32_bf16 v[184:187], v[48:51], v[144:147], 0
  v_mfma_f32_16x16x32_bf16 v[184:187], v[52:55], v[148:151], v[184:187]
  s_waitcnt lgkmcnt(0)
  v_mfma_f32_16x16x32_bf16 v[188:191], v[48:51], v[152:155], 0
  v_mfma_f32_16x16x32_bf16 v[188:191], v[52:55], v[156:159], v[188:191]
  s_lshl_b32 s80, s3, 11
  s_add_u32 s80, s80, 133120
  v_lshl_add_u32 v5, v2, 4, s80
  s_nop 6
  s_mov_b64 exec, s[92:93]
  ds_write_b128 v5, v[160:163] offset:0
  ds_write_b128 v5, v[164:167] offset:256
  ds_write_b128 v5, v[168:171] offset:512
  ds_write_b128 v5, v[172:175] offset:768
  ds_write_b128 v5, v[176:179] offset:1024
  ds_write_b128 v5, v[180:183] offset:1280
  ds_write_b128 v5, v[184:187] offset:1536
  ds_write_b128 v5, v[188:191] offset:1792
  s_mov_b64 exec, -1
  s_lshl_b32 s80, s3, 2
  s_add_u32 s80, s80, 133120
  v_lshlrev_b32 v5, 9, v1
  v_lshl_add_u32 v5, v2, 4, v5
  v_add_u32 v5, s80, v5
  s_lshl_b32 s80, s3, 3
  s_add_u32 s80, s80, 141312
  v_mov_b32 v6, s80
  s_waitcnt lgkmcnt(0)
  s_barrier
  ds_read_b64 v[40:41], v6 offset:0
  ds_read_b64 v[42:43], v6 offset:32
  ds_read_b64 v[44:45], v6 offset:64
  ds_read_b64 v[46:47], v6 offset:96
  ds_read_b32 v32, v5 offset:0
  ds_read_b32 v33, v5 offset:256
  ds_read_b32 v34, v5 offset:2048
  ds_read_b32 v35, v5 offset:2304
  ds_read_b32 v36, v5 offset:4096
  ds_read_b32 v37, v5 offset:4352
  ds_read_b32 v38, v5 offset:6144
  ds_read_b32 v39, v5 offset:6400
  s_lshr_b32 s80, s101, 3
  s_lshl_b32 s80, s80, 2
  s_add_u32 s80, s80, s3
  s_lshl_b32 s80, s80, 3
  s_and_b32 s81, s101, 7
  s_add_u32 s80, s80, s81
  s_lshl_b32 s100, s80, 10
  s_add_u32 s100, s100, 0x180000
  s_lshl_b32 s101, s80, 6
  s_add_u32 s101, s101, 0x200000
  v_mov_b32 v202, s72
  v_mov_b32 v203, s73
  v_mov_b32 v206, s72
  v_mov_b32 v207, s73
  s_waitcnt lgkmcnt(8)
  v_max3_f32 v204, v40, v42, v44
  v_max_f32 v204, v204, v46
  v_sub_f32 v48, v40, v204
  v_sub_f32 v49, v42, v204
  v_sub_f32 v50, v44, v204
  v_sub_f32 v51, v46, v204
  v_exp_f32 v48, v48
  v_exp_f32 v49, v49
  v_exp_f32 v50, v50
  v_exp_f32 v51, v51
  s_nop 0
  v_mul_f32 v205, v48, v41
  v_fma_f32 v205, v49, v43, v205
  v_fma_f32 v205, v50, v45, v205
  v_fma_f32 v205, v51, v47, v205
  s_waitcnt lgkmcnt(0)
  v_mul_f32 v200, v48, v32
  v_fma_f32 v200, v49, v34, v200
  v_fma_f32 v200, v50, v36, v200
  v_fma_f32 v200, v51, v38, v200
  v_mul_f32 v201, v48, v33
  v_fma_f32 v201, v49, v35, v201
  v_fma_f32 v201, v50, v37, v201
  v_fma_f32 v201, v51, v39, v201
  buffer_store_dwordx4 v[200:203], v15, s[68:71], s100 offen
  s_mov_b64 exec, 0xf
  buffer_store_dwordx4 v[204:207], v15, s[68:71], s101 offen
  s_mov_b64 exec, -1
  s_and_b32 s84, s2, 7
  s_bfe_u32 s85, s2, 0x40003
  s_lshr_b32 s98, s85, 2
  s_lshl_b32 s84, s84, 2
  s_add_u32 s98, s98, s84
  s_and_b32 s99, s85, 3
  s_cmp_lt_u32 s3, 2
  s_cbranch_scc1 L_TB_poll
  s_xor_b32 s89, s100, 0x2000000
  buffer_store_dwordx4 v[200:203], v15, s[68:71], s89 offen sc1
  s_mov_b64 exec, 0xf
  s_xor_b32 s89, s101, 0x2000000
  buffer_store_dwordx4 v[204:207], v15, s[68:71], s89 offen sc1
  s_mov_b64 exec, -1
  s_branch L_TB_wait
L_TB_poll:
  s_lshl_b32 s80, s3, 5
  s_add_u32 s80, s80, s98
  s_lshl_b32 s81, s80, 13
  s_add_u32 s81, s81, 0x180000
  s_add_u32 s82, s81, 4096
  s_lshl_b32 s83, s80, 9
  s_add_u32 s83, s83, 0x200000
  v_and_b32 v5, 7, v0
  v_lshlrev_b32 v5, 6, v5
  s_mov_b32 s75, 0
L_poll_tb_7:
  buffer_load_dwordx4 v[64:67], v5, s[68:71], s83 offen offset:0 sc1
  buffer_load_dwordx4 v[32:35], v15, s[68:71], s81 offen offset:0 sc1
  buffer_load_dwordx4 v[36:39], v15, s[68:71], s81 offen offset:1024 sc1
  buffer_load_dwordx4 v[40:43], v15, s[68:71], s81 offen offset:2048 sc1
  buffer_load_dwordx4 v[44:47], v15, s[68:71], s81 offen offset:3072 sc1
  buffer_load_dwordx4 v[48:51], v15, s[68:71], s82 offen offset:0 sc1
  buffer_load_dwordx4 v[52:55], v15, s[68:71], s82 offen offset:1024 sc1
  buffer_load_dwordx4 v[56:59], v15, s[68:71], s82 offen offset:2048 sc1
  buffer_load_dwordx4 v[60:63], v15, s[68:71], s82 offen offset:3072 sc1
  s_waitcnt vmcnt(0)
  v_cmp_eq_u64 vcc, s[72:73], v[66:67]
  v_cmp_eq_u64 s[96:97], s[72:73], v[34:35]
  s_and_b64 vcc, vcc, s[96:97]
  v_cmp_eq_u64 s[96:97], s[72:73], v[38:39]
  s_and_b64 vcc, vcc, s[96:97]
  v_cmp_eq_u64 s[96:97], s[72:73], v[42:43]
  s_and_b64 vcc, vcc, s[96:97]
  v_cmp_eq_u64 s[96:97], s[72:73], v[46:47]
  s_and_b64 vcc, vcc, s[96:97]
  v_cmp_eq_u64 s[96:97], s[72:73], v[50:51]
  s_and_b64 vcc, vcc, s[96:97]
  v_cmp_eq_u64 s[96:97], s[72:73], v[54:55]
  s_and_b64 vcc, vcc, s[96:97]
  v_cmp_eq_u64 s[96:97], s[72:73], v[58:59]
  s_and_b64 vcc, vcc, s[96:97]
  v_cmp_eq_u64 s[96:97], s[72:73], v[62:63]
  s_and_b64 vcc, vcc, s[96:97]
  s_cmp_eq_u64 vcc, exec
  s_cbranch_scc1 L_pdone_tb_8
  s_add_u32 s75, s75, 1
  s_cmp_lt_u32 s75, 64
  s_cbranch_scc1 L_poll_tb_7
  s_cmp_lg_u32 s75, 64
  s_cbranch_scc1 L_pfb_9
  s_xor_b32 s89, s100, 0x2000000
  buffer_store_dwordx4 v[200:203], v15, s[68:71], s89 offen sc1
  s_mov_b64 exec, 0xf
  s_xor_b32 s89, s101, 0x2000000
  buffer_store_dwordx4 v[204:207], v15, s[68:71], s89 offen sc1
  s_mov_b64 exec, -1
L_pfb_9:
  s_xor_b32 s81, s81, 0x2000000
  s_xor_b32 s82, s82, 0x2000000
  s_xor_b32 s83, s83, 0x2000000
  s_cmp_lt_u32 s75, 400000
  s_cbranch_scc1 L_poll_tb_7
L_pdone_tb_8:
  s_xor_b32 s89, s100, 0x2000000
  buffer_store_dwordx4 v[200:203], v15, s[68:71], s89 offen sc1
  s_mov_b64 exec, 0xf
  s_xor_b32 s89, s101, 0x2000000
  buffer_store_dwordx4 v[204:207], v15, s[68:71], s89 offen sc1
  s_mov_b64 exec, -1
  v_mov_b32 v6, v64
  s_nop 1
  v_max_f32_dpp v6, v6, v6 row_ror:4 row_mask:0xf bank_mask:0xf
  s_nop 1
  v_max_f32_dpp v6, v6, v6 row_ror:2 row_mask:0xf bank_mask:0xf
  s_nop 1
  v_max_f32_dpp v6, v6, v6 row_ror:1 row_mask:0xf bank_mask:0xf
  v_sub_f32 v7, v64, v6
  v_exp_f32 v7, v7
  s_nop 0
  v_mul_f32 v68, v7, v65
  s_nop 1
  v_add_f32_dpp v68, v68, v68 row_ror:4 row_mask:0xf bank_mask:0xf
  s_nop 1
  v_add_f32_dpp v68, v68, v68 row_ror:2 row_mask:0xf bank_mask:0xf
  s_nop 1
  v_add_f32_dpp v68, v68, v68 row_ror:1 row_mask:0xf bank_mask:0xf
  v_rcp_f32 v68, v68
  s_nop 0
  v_mul_f32 v7, v7, v68
  s_nop 0
  v_readlane_b32 s80, v7, 0
  v_readlane_b32 s81, v7, 1
  v_readlane_b32 s82, v7, 2
  v_readlane_b32 s83, v7, 3
  v_readlane_b32 s84, v7, 4
  v_readlane_b32 s85, v7, 5
  v_readlane_b32 s86, v7, 6
  v_readlane_b32 s87, v7, 7
  s_nop 1
  v_mul_f32 v68, s80, v32
  v_mul_f32 v69, s80, v33
  v_fma_f32 v68, s81, v36, v68
  v_fma_f32 v69, s81, v37, v69
  v_fma_f32 v68, s82, v40, v68
  v_fma_f32 v69, s82, v41, v69
  v_fma_f32 v68, s83, v44, v68
  v_fma_f32 v69, s83, v45, v69
  v_fma_f32 v68, s84, v48, v68
  v_fma_f32 v69, s84, v49, v69
  v_fma_f32 v68, s85, v52, v68
  v_fma_f32 v69, s85, v53, v69
  v_fma_f32 v68, s86, v56, v68
  v_fma_f32 v69, s86, v57, v69
  v_fma_f32 v68, s87, v60, v68
  v_fma_f32 v69, s87, v61, v69
  v_cvt_pk_bf16_f32 v68, v68, v69
  s_lshl_b32 s80, s3, 8
  s_add_u32 s80, s80, 143360
  v_lshlrev_b32 v5, 6, v1
  v_lshl_add_u32 v5, v2, 1, v5
  v_add_u32 v5, s80, v5
  ds_write_b16 v5, v68
  ds_write_b16_d16_hi v5, v68 offset:32
L_TB_wait:
  v_and_b32 v6, 1, v1
  v_lshl_or_b32 v6, v6, 2, v3
  v_lshlrev_b32 v6, 1, v6
  v_lshrrev_b32 v7, 1, v4
  v_xor_b32 v7, v7, v6
  v_lshlrev_b32 v7, 4, v7
  v_lshl_add_u32 v6, v1, 3, v3
  v_lshl_add_u32 v7, v6, 8, v7
  v_and_b32 v6, 1, v4
  v_lshl_add_u32 v76, v6, 3, v7
  s_lshl_b32 s89, s3, 6
  v_xor_b32 v76, s89, v76
  v_xor_b32 v77, 32, v76
  s_waitcnt vmcnt(0) lgkmcnt(0)
  s_barrier
  v_and_b32 v5, 1, v0
  v_mul_u32_u24 v5, 256, v5
  v_lshl_add_u32 v5, v1, 4, v5
  v_add_u32 v5, 0x23000, v5
  ds_read_b128 v[16:19], v5 offset:0
  ds_read_b128 v[20:23], v5 offset:64
  ds_read_b128 v[24:27], v5 offset:128
  ds_read_b128 v[28:31], v5 offset:192
  ds_read_b64_tr_b16 v[32:33], v76 offset:0
  ds_read_b64_tr_b16 v[34:35], v76 offset:1024
  ds_read_b64_tr_b16 v[36:37], v77 offset:0
  ds_read_b64_tr_b16 v[38:39], v77 offset:1024
  ds_read_b64_tr_b16 v[40:41], v76 offset:16384
  ds_read_b64_tr_b16 v[42:43], v76 offset:17408
  ds_read_b64_tr_b16 v[44:45], v77 offset:16384
  ds_read_b64_tr_b16 v[46:47], v77 offset:17408
  ds_read_b64_tr_b16 v[48:49], v76 offset:32768
  ds_read_b64_tr_b16 v[50:51], v76 offset:33792
  ds_read_b64_tr_b16 v[52:53], v77 offset:32768
  ds_read_b64_tr_b16 v[54:55], v77 offset:33792
  s_waitcnt lgkmcnt(8)
  v_mfma_f32_16x16x32_bf16 v[64:67], v[16:19], v[32:35], 0
  v_mfma_f32_16x16x32_bf16 v[68:71], v[16:19], v[36:39], 0
  ds_read_b64_tr_b16 v[56:57], v76 offset:49152
  ds_read_b64_tr_b16 v[58:59], v76 offset:50176
  ds_read_b64_tr_b16 v[60:61], v77 offset:49152
  ds_read_b64_tr_b16 v[62:63], v77 offset:50176
  s_waitcnt lgkmcnt(8)
  v_mfma_f32_16x16x32_bf16 v[64:67], v[20:23], v[40:43], v[64:67]
  v_mfma_f32_16x16x32_bf16 v[68:71], v[20:23], v[44:47], v[68:71]
  s_waitcnt lgkmcnt(4)
  v_mfma_f32_16x16x32_bf16 v[64:67], v[24:27], v[48:51], v[64:67]
  v_mfma_f32_16x16x32_bf16 v[68:71], v[24:27], v[52:55], v[68:71]
  s_waitcnt lgkmcnt(0)
  v_mfma_f32_16x16x32_bf16 v[64:67], v[28:31], v[56:59], v[64:67]
  v_mfma_f32_16x16x32_bf16 v[68:71], v[28:31], v[60:63], v[68:71]
  s_nop 8
  s_lshl_b32 s80, s99, 3
  s_lshl_b32 s81, s3, 1
  s_add_u32 s80, s80, s81
  s_lshl_b32 s80, s80, 13
  s_lshl_b32 s81, s98, 8
  s_add_u32 s80, s80, s81
  s_add_u32 s80, s80, 0x140000
  v_lshlrev_b32 v5, 13, v1
  v_lshl_add_u32 v5, v2, 4, v5
  v_cndmask_b32 v72, v68, v64, s[92:93]
  v_cndmask_b32 v73, v69, v65, s[92:93]
  v_mov_b32 v74, s72
  v_mov_b32 v75, s73
  s_mov_b64 exec, s[94:95]
  buffer_store_dwordx4 v[72:75], v5, s[68:71], s80 offen sc1
  s_mov_b64 exec, -1
  s_cmp_ge_u32 s2, 32
  s_cbranch_scc1 L_AB_fin
  s_cmp_lg_u32 s3, 0
  s_cbranch_scc1 L_AB_fin
  v_lshlrev_b32 v8, 4, v0
  s_lshl_b32 s76, s2, 13
  s_add_u32 s76, s76, 0x140000
  s_add_u32 s77, s76, 4096
  s_mov_b32 s75, 0
L_poll_fr1_10:
  buffer_load_dwordx4 v[12:15], v8, s[68:71], s76 offen offset:0 sc1
  buffer_load_dwordx4 v[16:19], v8, s[68:71], s76 offen offset:1024 sc1
  buffer_load_dwordx4 v[20:23], v8, s[68:71], s76 offen offset:2048 sc1
  buffer_load_dwordx4 v[24:27], v8, s[68:71], s76 offen offset:3072 sc1
  buffer_load_dwordx4 v[28:31], v8, s[68:71], s77 offen offset:0 sc1
  buffer_load_dwordx4 v[32:35], v8, s[68:71], s77 offen offset:1024 sc1
  buffer_load_dwordx4 v[36:39], v8, s[68:71], s77 offen offset:2048 sc1
  buffer_load_dwordx4 v[40:43], v8, s[68:71], s77 offen offset:3072 sc1
  s_waitcnt vmcnt(0)
  v_cmp_eq_u64 vcc, s[72:73], v[14:15]
  v_cmp_eq_u64 s[96:97], s[72:73], v[18:19]
  s_and_b64 vcc, vcc, s[96:97]
  v_cmp_eq_u64 s[96:97], s[72:73], v[22:23]
  s_and_b64 vcc, vcc, s[96:97]
  v_cmp_eq_u64 s[96:97], s[72:73], v[26:27]
  s_and_b64 vcc, vcc, s[96:97]
  v_cmp_eq_u64 s[96:97], s[72:73], v[30:31]
  s_and_b64 vcc, vcc, s[96:97]
  v_cmp_eq_u64 s[96:97], s[72:73], v[34:35]
  s_and_b64 vcc, vcc, s[96:97]
  v_cmp_eq_u64 s[96:97], s[72:73], v[38:39]
  s_and_b64 vcc, vcc, s[96:97]
  v_cmp_eq_u64 s[96:97], s[72:73], v[42:43]
  s_and_b64 vcc, vcc, s[96:97]
  s_cmp_eq_u64 vcc, exec
  s_cbranch_scc1 L_pdone_fr1_11
  s_add_u32 s75, s75, 1
  s_cmp_lt_u32 s75, 400000
  s_cbranch_scc1 L_poll_fr1_10
L_pdone_fr1_11:
  v_add_f32 v12, v12, v16
  v_add_f32 v20, v20, v24
  v_add_f32 v28, v28, v32
  v_add_f32 v36, v36, v40
  v_add_f32 v13, v13, v17
  v_add_f32 v21, v21, v25
  v_add_f32 v29, v29, v33
  v_add_f32 v37, v37, v41
  v_add_f32 v12, v12, v20
  v_add_f32 v28, v28, v36
  v_add_f32 v13, v13, v21
  v_add_f32 v29, v29, v37
  v_add_f32 v12, v12, v28
  v_add_f32 v13, v13, v29
  v_mov_b32 v14, v12
  v_mov_b32 v15, v13
  s_nop 0
  v_permlane32_swap_b32 v12, v14
  v_permlane32_swap_b32 v13, v15
  s_nop 0
  v_add_f32 v12, v12, v14
  v_add_f32 v13, v13, v15
  v_mov_b32 v14, v12
  v_mov_b32 v15, v13
  s_nop 0
  v_permlane16_swap_b32 v12, v14
  v_permlane16_swap_b32 v13, v15
  s_nop 0
  v_add_f32 v12, v12, v14
  v_add_f32 v13, v13, v15
  v_cvt_pk_bf16_f32 v12, v12, v13
  s_mov_b32 s64, s38
  s_and_b32 s65, s39, 0xffff
  s_mov_b32 s66, 0x1000
  s_mov_b32 s67, 0x20000
  v_lshlrev_b32 v8, 1, v2
  s_lshl_b32 s76, s2, 5
  s_add_u32 s76, s76, 1024
  s_add_u32 s77, s76, 2048
  s_mov_b64 exec, s[92:93]
  buffer_store_short v12, v8, s[64:67], s76 offen
  buffer_store_short_d16_hi v12, v8, s[64:67], s77 offen
  s_mov_b64 exec, -1
L_AB_fin:
  s_endpgm
L_help:
  s_setprio 3
  s_lshr_b32 s76, s2, 3
  s_and_b32 s76, s76, 19
  s_cmp_lg_u32 s76, 16
  s_cbranch_scc1 L_help_nopref
  s_sub_u32 s76, s3, 4
  s_lshl_b32 s76, s76, 10
  v_lshl_add_u32 v8, v0, 4, s76
  s_mov_b32 s77, L_code_end-concat_heads__compressed_kv_cla__sliding_block_cached__decode_kernel-32
  v_min_u32 v9, s77, v8
  global_load_dwordx4 v[200:203], v9, s[4:5]
  v_add_u32 v8, 0x1000, v8
  v_min_u32 v10, s77, v8
  global_load_dwordx4 v[204:207], v10, s[4:5]
  v_add_u32 v8, 0x1000, v8
  v_min_u32 v9, s77, v8
  global_load_dwordx4 v[208:211], v9, s[4:5]
  v_add_u32 v8, 0x1000, v8
  v_min_u32 v10, s77, v8
  global_load_dwordx4 v[212:215], v10, s[4:5]
  v_add_u32 v8, 0x1000, v8
  v_min_u32 v9, s77, v8
  global_load_dwordx4 v[216:219], v9, s[4:5]
  v_add_u32 v8, 0x1000, v8
  v_min_u32 v10, s77, v8
  global_load_dwordx4 v[220:223], v10, s[4:5]
  v_add_u32 v8, 0x1000, v8
  v_min_u32 v9, s77, v8
  global_load_dwordx4 v[224:227], v9, s[4:5]
  v_add_u32 v8, 0x1000, v8
L_help_nopref:
  s_cmp_ge_u32 s2, 128
  s_cbranch_scc1 L_AA_help
  s_cmp_lt_u32 s3, 7
  s_cbranch_scc1 L_help_b0
  v_lshlrev_b32 v20, 2, v0
  v_add_u32 v20, 0x27800, v20
  v_mov_b32 v21, 0
  ds_write_b32 v20, v21
  s_waitcnt lgkmcnt(0)
L_help_b0:
  s_barrier
  s_branch L_AB_load
L_AA_help:
  s_sub_u32 s100, s2, 128
  s_and_b32 s84, s2, 7
  s_bfe_u32 s85, s2, 0x40003
  s_lshr_b32 s98, s85, 2
  s_lshl_b32 s98, s98, 3
  s_add_u32 s98, s98, s84
  s_and_b32 s99, s85, 3
  s_sub_u32 s101, s3, 4
  v_lshlrev_b32 v15, 4, v0
  v_and_b32 v14, 31, v0
  v_lshlrev_b32 v14, 6, v14
  s_waitcnt lgkmcnt(0)
  s_mov_b32 s68, s42
  s_and_b32 s69, s43, 0xffff
  s_mov_b32 s70, 0x10000000
  s_mov_b32 s71, 0x20000
  s_load_dword s74, s[42:43], 0x0
  s_mov_b32 s48, s24
  s_and_b32 s49, s25, 0xffff
  s_mov_b32 s50, 0x400000
  s_mov_b32 s51, 0x20000
  s_mov_b32 s52, s26
  s_and_b32 s53, s27, 0xffff
  s_mov_b32 s54, 0x400000
  s_mov_b32 s55, 0x20000
  v_lshlrev_b32 v5, 1, v1
  v_xor_b32 v6, v5, v2
  v_lshlrev_b32 v6, 4, v6
  v_mul_u32_u24 v5, 8192, v1
  v_add_u32 v8, v5, v6
  v_xor_b32 v9, 0x80, v8
  v_lshlrev_b32 v5, 1, v1
  v_xor_b32 v6, v5, v2
  v_lshlrev_b32 v6, 4, v6
  v_mul_u32_u24 v5, 1024, v1
  v_add_u32 v10, v5, v6
  v_xor_b32 v11, 0x80, v10
  s_and_b32 s80, s101, 1
  s_lshl_b32 s80, s80, 4
  v_xor_b32 v16, s80, v15
  v_xor_b32 v17, 0x20, v16
  v_xor_b32 v18, 0x40, v16
  v_xor_b32 v19, 0x60, v16
  v_xor_b32 v20, 0x80, v16
  v_xor_b32 v21, 0xa0, v16
  v_xor_b32 v22, 0xc0, v16
  v_xor_b32 v23, 0xe0, v16
  s_and_b32 s77, s100, 7
  s_mul_i32 s77, s77, 8448
  s_lshl_b32 s76, s101, 11
  s_add_u32 s76, s76, s77
  s_add_u32 s76, s76, 0x300000
  s_lshr_b32 s77, s100, 6
  s_lshl_b32 s77, s77, 15
  s_lshl_b32 s78, s101, 13
  s_add_u32 s77, s77, s78
  s_add_u32 s77, s77, 0x50000
  s_add_u32 s78, s78, 131072
  s_waitcnt lgkmcnt(0)
  s_mul_i32 s72, s74, 1664525
  s_add_u32 s72, s72, 1013904223
  s_xor_b32 s73, s72, 0x5bd1e995
  s_mov_b32 s75, 0
L_poll_qflag_19:
  buffer_load_dwordx4 v[24:27], v14, s[68:71], s76 offen offset:0 sc1
  s_waitcnt vmcnt(0)
  v_cmp_eq_u64 vcc, s[72:73], v[26:27]
  s_cmp_eq_u64 vcc, exec
  s_cbranch_scc1 L_pdone_qflag_20
  s_add_u32 s75, s75, 1
  s_sleep 2
  s_cmp_lt_u32 s75, 400000
  s_cbranch_scc1 L_poll_qflag_19
L_pdone_qflag_20:
  s_add_u32 m0, s78, 0
  s_add_u32 s79, s77, 0
  buffer_load_dwordx4 v16, s[68:71], s79 offen offset:0 sc1 lds
  buffer_load_dwordx4 v17, s[68:71], s79 offen offset:1024 sc1 lds
  buffer_load_dwordx4 v18, s[68:71], s79 offen offset:2048 sc1 lds
  buffer_load_dwordx4 v19, s[68:71], s79 offen offset:3072 sc1 lds
  s_add_u32 m0, s78, 4096
  s_add_u32 s79, s77, 4096
  buffer_load_dwordx4 v20, s[68:71], s79 offen offset:0 sc1 lds
  buffer_load_dwordx4 v21, s[68:71], s79 offen offset:1024 sc1 lds
  buffer_load_dwordx4 v22, s[68:71], s79 offen offset:2048 sc1 lds
  buffer_load_dwordx4 v23, s[68:71], s79 offen offset:3072 sc1 lds
  s_lshl_b32 s76, s99, 20
  s_lshl_b32 s77, s98, 8
  s_add_u32 s76, s76, s77
  s_lshl_b32 s77, s101, 18
  s_add_u32 s76, s76, s77
  s_lshl_b32 s77, s101, 13
  s_lshl_b32 s80, s98, 17
  s_lshl_b32 s81, s99, 8
  s_add_u32 s80, s80, s81
  s_lshl_b32 s81, s101, 15
  s_add_u32 s80, s80, s81
  s_add_u32 s81, s77, 32768
  s_waitcnt vmcnt(0)
  s_barrier
  s_add_u32 s88, s76, 0
  buffer_load_dwordx4 v[64:67], v8, s[48:51], s88 offen nt
  s_add_u32 s88, s76, 32768
  buffer_load_dwordx4 v[68:71], v8, s[48:51], s88 offen nt
  s_add_u32 s88, s76, 65536
  buffer_load_dwordx4 v[72:75], v9, s[48:51], s88 offen nt
  s_add_u32 s88, s76, 98304
  buffer_load_dwordx4 v[76:79], v9, s[48:51], s88 offen nt
  s_add_u32 s88, s76, 131072
  buffer_load_dwordx4 v[80:83], v8, s[48:51], s88 offen nt
  s_add_u32 s88, s76, 163840
  buffer_load_dwordx4 v[84:87], v8, s[48:51], s88 offen nt
  s_add_u32 s88, s76, 196608
  buffer_load_dwordx4 v[88:91], v9, s[48:51], s88 offen nt
  s_add_u32 s88, s76, 229376
  buffer_load_dwordx4 v[92:95], v9, s[48:51], s88 offen nt
  s_add_u32 s88, s80, 0
  buffer_load_dwordx4 v[96:99], v10, s[52:55], s88 offen nt
  s_add_u32 s88, s80, 4096
  buffer_load_dwordx4 v[100:103], v10, s[52:55], s88 offen nt
  s_add_u32 s88, s80, 8192
  buffer_load_dwordx4 v[104:107], v11, s[52:55], s88 offen nt
  s_add_u32 s88, s80, 12288
  buffer_load_dwordx4 v[108:111], v11, s[52:55], s88 offen nt
  s_barrier
  s_barrier
  s_barrier
  s_add_u32 s88, s80, 16384
  buffer_load_dwordx4 v[112:115], v10, s[52:55], s88 offen nt
  s_add_u32 s88, s80, 20480
  buffer_load_dwordx4 v[116:119], v10, s[52:55], s88 offen nt
  s_add_u32 s88, s80, 24576
  buffer_load_dwordx4 v[120:123], v11, s[52:55], s88 offen nt
  s_add_u32 s88, s80, 28672
  buffer_load_dwordx4 v[124:127], v11, s[52:55], s88 offen nt
  v_add_u32 v12, s77, v15
  s_barrier
  s_waitcnt vmcnt(8)
  ds_write_b128 v12, v[64:67] offset:0
  ds_write_b128 v12, v[68:71] offset:1024
  ds_write_b128 v12, v[72:75] offset:2048
  ds_write_b128 v12, v[76:79] offset:3072
  ds_write_b128 v12, v[80:83] offset:4096
  ds_write_b128 v12, v[84:87] offset:5120
  ds_write_b128 v12, v[88:91] offset:6144
  ds_write_b128 v12, v[92:95] offset:7168
  s_barrier
  s_waitcnt vmcnt(0)
  ds_write_b128 v12, v[96:99] offset:32768
  ds_write_b128 v12, v[100:103] offset:33792
  ds_write_b128 v12, v[104:107] offset:34816
  ds_write_b128 v12, v[108:111] offset:35840
  ds_write_b128 v12, v[112:115] offset:36864
  ds_write_b128 v12, v[116:119] offset:37888
  ds_write_b128 v12, v[120:123] offset:38912
  ds_write_b128 v12, v[124:127] offset:39936
  s_waitcnt lgkmcnt(0)
  s_barrier
  s_endpgm
L_AA:
  s_sub_u32 s100, s2, 128
  v_lshlrev_b32 v15, 4, v0
  v_xor_b32 v16, 0x0, v15
  v_xor_b32 v17, 0x20, v15
  v_xor_b32 v18, 0x40, v15
  v_xor_b32 v19, 0x60, v15
  v_xor_b32 v20, 0x80, v15
  v_xor_b32 v21, 0xa0, v15
  v_xor_b32 v22, 0xc0, v15
  v_xor_b32 v23, 0xe0, v15
  v_xor_b32 v24, 0x10, v15
  v_xor_b32 v25, 0x30, v15
  v_xor_b32 v26, 0x50, v15
  v_xor_b32 v27, 0x70, v15
  v_xor_b32 v28, 0x90, v15
  v_xor_b32 v29, 0xb0, v15
  v_xor_b32 v30, 0xd0, v15
  v_xor_b32 v31, 0xf0, v15
  s_lshl_b32 s76, s100, 17
  s_lshl_b32 s77, s3, 15
  s_add_u32 s76, s76, s77
  s_waitcnt lgkmcnt(0)
  s_mov_b32 s44, s18
  s_and_b32 s45, s19, 0xffff
  s_mov_b32 s46, 0x1000000
  s_mov_b32 s47, 0x20000
  s_load_dword s74, s[42:43], 0x0
  s_mov_b32 s68, s42
  s_and_b32 s69, s43, 0xffff
  s_mov_b32 s70, 0x10000000
  s_mov_b32 s71, 0x20000
  s_waitcnt lgkmcnt(0)
  s_mul_i32 s72, s74, 1664525
  s_add_u32 s72, s72, 1013904223
  s_xor_b32 s73, s72, 0x5bd1e995
  s_add_u32 m0, s77, 0
  s_add_u32 s79, s76, 0
  buffer_load_dwordx4 v16, s[44:47], s79 offen offset:0 nt lds
  buffer_load_dwordx4 v17, s[44:47], s79 offen offset:1024 nt lds
  buffer_load_dwordx4 v18, s[44:47], s79 offen offset:2048 nt lds
  buffer_load_dwordx4 v19, s[44:47], s79 offen offset:3072 nt lds
  s_add_u32 m0, s77, 4096
  s_add_u32 s79, s76, 4096
  buffer_load_dwordx4 v20, s[44:47], s79 offen offset:0 nt lds
  buffer_load_dwordx4 v21, s[44:47], s79 offen offset:1024 nt lds
  buffer_load_dwordx4 v22, s[44:47], s79 offen offset:2048 nt lds
  buffer_load_dwordx4 v23, s[44:47], s79 offen offset:3072 nt lds
  s_add_u32 m0, s77, 8192
  s_add_u32 s79, s76, 8192
  buffer_load_dwordx4 v24, s[44:47], s79 offen offset:0 nt lds
  buffer_load_dwordx4 v25, s[44:47], s79 offen offset:1024 nt lds
  s_waitcnt vmcnt(9)
  buffer_load_dwordx4 v26, s[44:47], s79 offen offset:2048 nt lds
  s_waitcnt vmcnt(9)
  buffer_load_dwordx4 v27, s[44:47], s79 offen offset:3072 nt lds
  s_waitcnt vmcnt(9)
  s_add_u32 m0, s77, 12288
  s_add_u32 s79, s76, 12288
  buffer_load_dwordx4 v28, s[44:47], s79 offen offset:0 nt lds
  s_waitcnt vmcnt(9)
  buffer_load_dwordx4 v29, s[44:47], s79 offen offset:1024 nt lds
  s_waitcnt vmcnt(9)
  buffer_load_dwordx4 v30, s[44:47], s79 offen offset:2048 nt lds
  s_waitcnt vmcnt(9)
  buffer_load_dwordx4 v31, s[44:47], s79 offen offset:3072 nt lds
  s_waitcnt vmcnt(9)
  s_add_u32 m0, s77, 16384
  s_add_u32 s79, s76, 16384
  buffer_load_dwordx4 v16, s[44:47], s79 offen offset:0 nt lds
  s_waitcnt vmcnt(9)
  buffer_load_dwordx4 v17, s[44:47], s79 offen offset:1024 nt lds
  s_waitcnt vmcnt(9)
  buffer_load_dwordx4 v18, s[44:47], s79 offen offset:2048 nt lds
  s_waitcnt vmcnt(9)
  buffer_load_dwordx4 v19, s[44:47], s79 offen offset:3072 nt lds
  s_waitcnt vmcnt(9)
  s_add_u32 m0, s77, 20480
  s_add_u32 s79, s76, 20480
  buffer_load_dwordx4 v20, s[44:47], s79 offen offset:0 nt lds
  s_waitcnt vmcnt(9)
  buffer_load_dwordx4 v21, s[44:47], s79 offen offset:1024 nt lds
  s_waitcnt vmcnt(9)
  buffer_load_dwordx4 v22, s[44:47], s79 offen offset:2048 nt lds
  s_waitcnt vmcnt(9)
  buffer_load_dwordx4 v23, s[44:47], s79 offen offset:3072 nt lds
  s_waitcnt vmcnt(9)
  s_add_u32 m0, s77, 24576
  s_add_u32 s79, s76, 24576
  buffer_load_dwordx4 v24, s[44:47], s79 offen offset:0 nt lds
  s_waitcnt vmcnt(9)
  buffer_load_dwordx4 v25, s[44:47], s79 offen offset:1024 nt lds
  s_waitcnt vmcnt(9)
  buffer_load_dwordx4 v26, s[44:47], s79 offen offset:2048 nt lds
  s_waitcnt vmcnt(9)
  buffer_load_dwordx4 v27, s[44:47], s79 offen offset:3072 nt lds
  s_waitcnt vmcnt(9)
  s_add_u32 m0, s77, 28672
  s_add_u32 s79, s76, 28672
  buffer_load_dwordx4 v28, s[44:47], s79 offen offset:0 nt lds
  s_waitcnt vmcnt(9)
  buffer_load_dwordx4 v29, s[44:47], s79 offen offset:1024 nt lds
  s_waitcnt vmcnt(9)
  buffer_load_dwordx4 v30, s[44:47], s79 offen offset:2048 nt lds
  s_waitcnt vmcnt(9)
  buffer_load_dwordx4 v31, s[44:47], s79 offen offset:3072 nt lds
L_AA_2:
  s_and_b32 s84, s2, 7
  s_bfe_u32 s85, s2, 0x40003
  s_lshr_b32 s98, s85, 2
  s_lshl_b32 s98, s98, 3
  s_add_u32 s98, s98, s84
  s_and_b32 s99, s85, 3
  s_mov_b32 s68, s42
  s_and_b32 s69, s43, 0xffff
  s_mov_b32 s70, 0x10000000
  s_mov_b32 s71, 0x20000
  v_and_b32 v5, 7, v0
  v_lshlrev_b32 v5, 1, v5
  v_bfe_u32 v6, v0, 3, 1
  v_or_b32 v5, v5, v6
  v_lshrrev_b32 v6, 5, v0
  v_xor_b32 v5, v5, v6
  v_lshlrev_b32 v5, 4, v5
  v_and_b32 v6, 31, v0
  v_lshl_add_u32 v5, v6, 10, v5
  v_add_u32 v24, s77, v5
  v_add_u32 v32, 0x20000, v5
  v_xor_b32 v25, 0x20, v24
  v_xor_b32 v33, 0x20, v32
  v_xor_b32 v26, 0x40, v24
  v_xor_b32 v34, 0x40, v32
  v_xor_b32 v27, 0x60, v24
  v_xor_b32 v35, 0x60, v32
  v_xor_b32 v28, 0x80, v24
  v_xor_b32 v36, 0x80, v32
  v_xor_b32 v29, 0xa0, v24
  v_xor_b32 v37, 0xa0, v32
  v_xor_b32 v30, 0xc0, v24
  v_xor_b32 v38, 0xc0, v32
  v_xor_b32 v31, 0xe0, v24
  v_xor_b32 v39, 0xe0, v32
  v_and_b32 v5, 1, v1
  v_lshl_or_b32 v5, v5, 2, v3
  v_lshlrev_b32 v6, 1, v5
  v_lshrrev_b32 v7, 1, v4
  v_or_b32 v6, v6, v7
  v_lshlrev_b32 v6, 4, v6
  v_lshrrev_b32 v7, 1, v1
  v_lshl_add_u32 v5, v7, 4, v5
  v_lshl_add_u32 v6, v5, 10, v6
  v_and_b32 v7, 1, v4
  v_lshl_add_u32 v6, v7, 3, v6
  s_lshl_b32 s80, s3, 8
  v_add_u32 v184, s80, v6
  v_xor_b32 v185, 0x10, v184
  v_xor_b32 v186, 0x20, v184
  v_xor_b32 v187, 0x30, v184
  v_xor_b32 v188, 0x40, v184
  v_xor_b32 v189, 0x50, v184
  v_xor_b32 v190, 0x60, v184
  v_xor_b32 v191, 0x70, v184
  v_xor_b32 v192, 0x80, v184
  v_xor_b32 v193, 0x90, v184
  v_xor_b32 v194, 0xa0, v184
  v_xor_b32 v195, 0xb0, v184
  v_xor_b32 v196, 0xc0, v184
  v_xor_b32 v197, 0xd0, v184
  v_xor_b32 v198, 0xe0, v184
  v_xor_b32 v199, 0xf0, v184
  v_lshrrev_b32 v5, 1, v1
  v_lshlrev_b32 v5, 6, v5
  v_and_b32 v6, 1, v1
  v_lshl_add_u32 v5, v6, 5, v5
  v_add_u32 v5, v5, v2
  v_lshlrev_b32 v5, 4, v5
  v_add_u32 v13, 0x20000, v5
  s_lshl_b32 s80, s3, 11
  s_add_u32 s80, s80, 131072
  v_add_u32 v217, s80, v15
  v_and_b32 v7, 31, v0
  v_lshlrev_b32 v7, 2, v7
  s_lshl_b32 s80, s3, 7
  s_add_u32 s80, s80, 139264
  v_add_u32 v218, s80, v7
  v_add_u32 v219, 0x22000, v7
  v_lshlrev_b32 v5, 18, v1
  v_lshl_add_u32 v5, v2, 4, v5
  s_lshl_b32 s80, s3, 8
  v_add_u32 v216, s80, v5
  s_lshr_b32 s80, s100, 6
  s_lshl_b32 s80, s80, 21
  s_and_b32 s81, s100, 63
  s_lshl_b32 s81, s81, 10
  s_add_u32 s80, s80, s81
  s_add_u32 s83, s80, 0x400000
  s_mov_b32 s82, 0x3e0293ee
  s_waitcnt lgkmcnt(0)
  s_mul_i32 s72, s74, 1664525
  s_add_u32 s72, s72, 1013904223
  s_xor_b32 s73, s72, 0x5bd1e995
  s_waitcnt vmcnt(0)
  ds_read_b128 v[56:59], v24 offset:0
  ds_read_b128 v[64:67], v25 offset:0
  ds_read_b128 v[72:75], v26 offset:0
  ds_read_b128 v[80:83], v27 offset:0
  ds_read_b128 v[88:91], v28 offset:0
  ds_read_b128 v[96:99], v29 offset:0
  s_barrier
  ds_read_b128 v[60:63], v32 offset:0
  ds_read_b128 v[68:71], v33 offset:0
  ds_read_b128 v[76:79], v34 offset:0
  ds_read_b128 v[84:87], v35 offset:0
  ds_read_b128 v[92:95], v36 offset:0
  ds_read_b128 v[100:103], v37 offset:0
  s_waitcnt lgkmcnt(4)
  v_mfma_f32_32x32x16_bf16 v[40:55], v[56:59], v[60:63], 0
  v_mfma_f32_32x32x16_bf16 v[40:55], v[64:67], v[68:71], v[40:55]
  ds_read_b128 v[104:107], v30 offset:0
  ds_read_b128 v[112:115], v31 offset:0
  ds_read_b128 v[108:111], v38 offset:0
  ds_read_b128 v[116:119], v39 offset:0
  s_waitcnt lgkmcnt(6)
  v_mfma_f32_32x32x16_bf16 v[40:55], v[72:75], v[76:79], v[40:55]
  v_mfma_f32_32x32x16_bf16 v[40:55], v[80:83], v[84:87], v[40:55]
  ds_read_b128 v[56:59], v24 offset:256
  ds_read_b128 v[64:67], v25 offset:256
  ds_read_b128 v[60:63], v32 offset:256
  ds_read_b128 v[68:71], v33 offset:256
  s_waitcnt lgkmcnt(8)
  v_mfma_f32_32x32x16_bf16 v[40:55], v[88:91], v[92:95], v[40:55]
  v_mfma_f32_32x32x16_bf16 v[40:55], v[96:99], v[100:103], v[40:55]
  ds_read_b128 v[72:75], v26 offset:256
  ds_read_b128 v[80:83], v27 offset:256
  ds_read_b128 v[76:79], v34 offset:256
  ds_read_b128 v[84:87], v35 offset:256
  s_waitcnt lgkmcnt(8)
  v_mfma_f32_32x32x16_bf16 v[40:55], v[104:107], v[108:111], v[40:55]
  v_mfma_f32_32x32x16_bf16 v[40:55], v[112:115], v[116:119], v[40:55]
  ds_read_b128 v[88:91], v28 offset:256
  ds_read_b128 v[96:99], v29 offset:256
  ds_read_b128 v[92:95], v36 offset:256
  ds_read_b128 v[100:103], v37 offset:256
  s_waitcnt lgkmcnt(8)
  v_mfma_f32_32x32x16_bf16 v[40:55], v[56:59], v[60:63], v[40:55]
  v_mfma_f32_32x32x16_bf16 v[40:55], v[64:67], v[68:71], v[40:55]
  ds_read_b128 v[104:107], v30 offset:256
  ds_read_b128 v[112:115], v31 offset:256
  ds_read_b128 v[108:111], v38 offset:256
  ds_read_b128 v[116:119], v39 offset:256
  s_waitcnt lgkmcnt(8)
  v_mfma_f32_32x32x16_bf16 v[40:55], v[72:75], v[76:79], v[40:55]
  v_mfma_f32_32x32x16_bf16 v[40:55], v[80:83], v[84:87], v[40:55]
  ds_read_b128 v[56:59], v24 offset:512
  ds_read_b128 v[64:67], v25 offset:512
  ds_read_b128 v[60:63], v32 offset:512
  ds_read_b128 v[68:71], v33 offset:512
  s_waitcnt lgkmcnt(8)
  v_mfma_f32_32x32x16_bf16 v[40:55], v[88:91], v[92:95], v[40:55]
  v_mfma_f32_32x32x16_bf16 v[40:55], v[96:99], v[100:103], v[40:55]
  ds_read_b128 v[72:75], v26 offset:512
  ds_read_b128 v[80:83], v27 offset:512
  ds_read_b128 v[76:79], v34 offset:512
  ds_read_b128 v[84:87], v35 offset:512
  s_waitcnt lgkmcnt(8)
  v_mfma_f32_32x32x16_bf16 v[40:55], v[104:107], v[108:111], v[40:55]
  v_mfma_f32_32x32x16_bf16 v[40:55], v[112:115], v[116:119], v[40:55]
  ds_read_b128 v[88:91], v28 offset:512
  ds_read_b128 v[96:99], v29 offset:512
  ds_read_b128 v[92:95], v36 offset:512
  ds_read_b128 v[100:103], v37 offset:512
  s_waitcnt lgkmcnt(8)
  v_mfma_f32_32x32x16_bf16 v[40:55], v[56:59], v[60:63], v[40:55]
  v_mfma_f32_32x32x16_bf16 v[40:55], v[64:67], v[68:71], v[40:55]
  ds_read_b128 v[104:107], v30 offset:512
  ds_read_b128 v[112:115], v31 offset:512
  ds_read_b128 v[108:111], v38 offset:512
  ds_read_b128 v[116:119], v39 offset:512
  s_waitcnt lgkmcnt(8)
  v_mfma_f32_32x32x16_bf16 v[40:55], v[72:75], v[76:79], v[40:55]
  v_mfma_f32_32x32x16_bf16 v[40:55], v[80:83], v[84:87], v[40:55]
  ds_read_b128 v[56:59], v24 offset:768
  ds_read_b128 v[64:67], v25 offset:768
  ds_read_b128 v[60:63], v32 offset:768
  ds_read_b128 v[68:71], v33 offset:768
  s_waitcnt lgkmcnt(8)
  v_mfma_f32_32x32x16_bf16 v[40:55], v[88:91], v[92:95], v[40:55]
  v_mfma_f32_32x32x16_bf16 v[40:55], v[96:99], v[100:103], v[40:55]
  ds_read_b128 v[72:75], v26 offset:768
  ds_read_b128 v[80:83], v27 offset:768
  ds_read_b128 v[76:79], v34 offset:768
  ds_read_b128 v[84:87], v35 offset:768
  s_waitcnt lgkmcnt(8)
  v_mfma_f32_32x32x16_bf16 v[40:55], v[104:107], v[108:111], v[40:55]
  v_mfma_f32_32x32x16_bf16 v[40:55], v[112:115], v[116:119], v[40:55]
  ds_read_b128 v[88:91], v28 offset:768
  ds_read_b128 v[96:99], v29 offset:768
  ds_read_b128 v[92:95], v36 offset:768
  ds_read_b128 v[100:103], v37 offset:768
  s_waitcnt lgkmcnt(8)
  v_mfma_f32_32x32x16_bf16 v[40:55], v[56:59], v[60:63], v[40:55]
  v_mfma_f32_32x32x16_bf16 v[40:55], v[64:67], v[68:71], v[40:55]
  ds_read_b128 v[104:107], v30 offset:768
  ds_read_b128 v[112:115], v31 offset:768
  ds_read_b128 v[108:111], v38 offset:768
  ds_read_b128 v[116:119], v39 offset:768
  s_waitcnt lgkmcnt(8)
  v_mfma_f32_32x32x16_bf16 v[40:55], v[72:75], v[76:79], v[40:55]
  v_mfma_f32_32x32x16_bf16 v[40:55], v[80:83], v[84:87], v[40:55]
  s_waitcnt lgkmcnt(4)
  v_mfma_f32_32x32x16_bf16 v[40:55], v[88:91], v[92:95], v[40:55]
  v_mfma_f32_32x32x16_bf16 v[40:55], v[96:99], v[100:103], v[40:55]
  s_waitcnt lgkmcnt(0)
  v_mfma_f32_32x32x16_bf16 v[40:55], v[104:107], v[108:111], v[40:55]
  v_mfma_f32_32x32x16_bf16 v[40:55], v[112:115], v[116:119], v[40:55]
  s_nop 12
  v_max3_f32 v8, v40, v41, v42
  v_max3_f32 v9, v43, v44, v45
  v_max3_f32 v10, v46, v47, v48
  v_max3_f32 v11, v49, v50, v51
  v_max3_f32 v5, v52, v53, v54
  v_max3_f32 v8, v8, v9, v10
  v_max3_f32 v5, v5, v11, v55
  v_max_f32 v5, v5, v8
  v_mov_b32 v6, v5
  s_nop 1
  v_permlane32_swap_b32 v5, v6
  s_nop 0
  v_max_f32 v5, v5, v6
  s_barrier
  ds_write_b32 v218, v5
  v_mul_f32 v12, s82, v5
  v_fma_f32 v40, v40, s82, -v12
  v_fma_f32 v41, v41, s82, -v12
  v_fma_f32 v42, v42, s82, -v12
  v_fma_f32 v43, v43, s82, -v12
  v_fma_f32 v44, v44, s82, -v12
  v_fma_f32 v45, v45, s82, -v12
  v_fma_f32 v46, v46, s82, -v12
  v_fma_f32 v47, v47, s82, -v12
  v_fma_f32 v48, v48, s82, -v12
  v_fma_f32 v49, v49, s82, -v12
  v_fma_f32 v50, v50, s82, -v12
  v_fma_f32 v51, v51, s82, -v12
  v_fma_f32 v52, v52, s82, -v12
  v_fma_f32 v53, v53, s82, -v12
  v_fma_f32 v54, v54, s82, -v12
  v_fma_f32 v55, v55, s82, -v12
  s_waitcnt lgkmcnt(0)
  s_barrier
  ds_read_b32 v8, v219 offset:0
  ds_read_b32 v9, v219 offset:128
  ds_read_b32 v10, v219 offset:256
  ds_read_b32 v11, v219 offset:384
  v_exp_f32 v40, v40
  v_exp_f32 v41, v41
  v_exp_f32 v42, v42
  v_exp_f32 v43, v43
  v_exp_f32 v44, v44
  v_exp_f32 v45, v45
  v_exp_f32 v46, v46
  v_exp_f32 v47, v47
  v_exp_f32 v48, v48
  v_exp_f32 v49, v49
  v_exp_f32 v50, v50
  v_exp_f32 v51, v51
  v_exp_f32 v52, v52
  v_exp_f32 v53, v53
  v_exp_f32 v54, v54
  v_exp_f32 v55, v55
  v_add_f32 v6, v40, v41
  v_add_f32 v7, v42, v43
  v_add_f32 v6, v6, v44
  v_add_f32 v7, v7, v45
  v_add_f32 v6, v6, v46
  v_add_f32 v7, v7, v47
  v_add_f32 v6, v6, v48
  v_add_f32 v7, v7, v49
  v_add_f32 v6, v6, v50
  v_add_f32 v7, v7, v51
  v_add_f32 v6, v6, v52
  v_add_f32 v7, v7, v53
  v_add_f32 v6, v6, v54
  v_add_f32 v7, v7, v55
  v_add_f32 v14, v6, v7
  s_waitcnt lgkmcnt(0)
  v_max3_f32 v5, v8, v9, v10
  v_max_f32 v5, v5, v11
  v_mul_f32 v5, s82, v5
  v_sub_f32 v6, v12, v5
  v_exp_f32 v6, v6
  v_mov_b32 v12, v5
  ds_read_b64_tr_b16 v[88:89], v184 offset:0
  ds_read_b64_tr_b16 v[90:91], v185 offset:8192
  ds_read_b64_tr_b16 v[92:93], v186 offset:0
  ds_read_b64_tr_b16 v[94:95], v187 offset:8192
  ds_read_b64_tr_b16 v[96:97], v188 offset:0
  ds_read_b64_tr_b16 v[98:99], v189 offset:8192
  ds_read_b64_tr_b16 v[100:101], v190 offset:0
  ds_read_b64_tr_b16 v[102:103], v191 offset:8192
  ds_read_b64_tr_b16 v[104:105], v192 offset:0
  ds_read_b64_tr_b16 v[106:107], v193 offset:8192
  ds_read_b64_tr_b16 v[108:109], v194 offset:0
  ds_read_b64_tr_b16 v[110:111], v195 offset:8192
  v_mul_f32 v40, v40, v6
  v_mul_f32 v41, v41, v6
  v_mul_f32 v42, v42, v6
  v_mul_f32 v43, v43, v6
  v_mul_f32 v44, v44, v6
  v_mul_f32 v45, v45, v6
  v_mul_f32 v46, v46, v6
  v_mul_f32 v47, v47, v6
  v_mul_f32 v48, v48, v6
  v_mul_f32 v49, v49, v6
  v_mul_f32 v50, v50, v6
  v_mul_f32 v51, v51, v6
  v_mul_f32 v52, v52, v6
  v_mul_f32 v53, v53, v6
  v_mul_f32 v54, v54, v6
  v_mul_f32 v55, v55, v6
  v_cvt_pk_bf16_f32 v56, v40, v41
  v_cvt_pk_bf16_f32 v57, v42, v43
  v_cvt_pk_bf16_f32 v58, v44, v45
  v_cvt_pk_bf16_f32 v59, v46, v47
  v_cvt_pk_bf16_f32 v60, v48, v49
  v_cvt_pk_bf16_f32 v61, v50, v51
  v_cvt_pk_bf16_f32 v62, v52, v53
  v_cvt_pk_bf16_f32 v63, v54, v55
  ds_write_b128 v217, v[56:59]
  ds_write_b128 v217, v[60:63] offset:1024
  v_mul_f32 v14, v14, v6
  v_mov_b32 v9, v14
  s_nop 1
  v_permlane32_swap_b32 v14, v9
  s_nop 0
  v_add_f32 v14, v14, v9
  ds_write_b32 v218, v14 offset:512
  s_waitcnt lgkmcnt(0)
  s_barrier
  ds_read_b128 v[56:59], v13 offset:0
  ds_read_b128 v[60:63], v13 offset:256
  ds_read_b128 v[64:67], v13 offset:2048
  ds_read_b128 v[68:71], v13 offset:2304
  ds_read_b128 v[72:75], v13 offset:4096
  ds_read_b128 v[76:79], v13 offset:4352
  ds_read_b128 v[80:83], v13 offset:6144
  ds_read_b128 v[84:87], v13 offset:6400
  ds_read_b32 v8, v219 offset:512
  ds_read_b32 v9, v219 offset:640
  ds_read_b32 v10, v219 offset:768
  ds_read_b32 v11, v219 offset:896
  s_waitcnt lgkmcnt(10)
  v_mfma_f32_16x16x32_bf16 v[120:123], v[56:59], v[88:91], 0
  v_mfma_f32_16x16x32_bf16 v[124:127], v[56:59], v[92:95], 0
  v_mfma_f32_16x16x32_bf16 v[152:155], v[60:63], v[88:91], 0
  v_mfma_f32_16x16x32_bf16 v[156:159], v[60:63], v[92:95], 0
  ds_read_b64_tr_b16 v[112:113], v196 offset:0
  ds_read_b64_tr_b16 v[114:115], v197 offset:8192
  ds_read_b64_tr_b16 v[116:117], v198 offset:0
  ds_read_b64_tr_b16 v[118:119], v199 offset:8192
  s_waitcnt lgkmcnt(10)
  v_mfma_f32_16x16x32_bf16 v[128:131], v[56:59], v[96:99], 0
  v_mfma_f32_16x16x32_bf16 v[132:135], v[56:59], v[100:103], 0
  v_mfma_f32_16x16x32_bf16 v[160:163], v[60:63], v[96:99], 0
  v_mfma_f32_16x16x32_bf16 v[164:167], v[60:63], v[100:103], 0
  ds_read_b64_tr_b16 v[88:89], v184 offset:32768
  ds_read_b64_tr_b16 v[90:91], v185 offset:40960
  ds_read_b64_tr_b16 v[92:93], v186 offset:32768
  ds_read_b64_tr_b16 v[94:95], v187 offset:40960
  s_waitcnt lgkmcnt(10)
  v_mfma_f32_16x16x32_bf16 v[136:139], v[56:59], v[104:107], 0
  v_mfma_f32_16x16x32_bf16 v[140:143], v[56:59], v[108:111], 0
  v_mfma_f32_16x16x32_bf16 v[168:171], v[60:63], v[104:107], 0
  v_mfma_f32_16x16x32_bf16 v[172:175], v[60:63], v[108:111], 0
  ds_read_b64_tr_b16 v[96:97], v188 offset:32768
  ds_read_b64_tr_b16 v[98:99], v189 offset:40960
  ds_read_b64_tr_b16 v[100:101], v190 offset:32768
  ds_read_b64_tr_b16 v[102:103], v191 offset:40960
  s_waitcnt lgkmcnt(8)
  v_mfma_f32_16x16x32_bf16 v[144:147], v[56:59], v[112:115], 0
  v_mfma_f32_16x16x32_bf16 v[148:151], v[56:59], v[116:119], 0
  v_mfma_f32_16x16x32_bf16 v[176:179], v[60:63], v[112:115], 0
  v_mfma_f32_16x16x32_bf16 v[180:183], v[60:63], v[116:119], 0
  ds_read_b64_tr_b16 v[104:105], v192 offset:32768
  ds_read_b64_tr_b16 v[106:107], v193 offset:40960
  ds_read_b64_tr_b16 v[108:109], v194 offset:32768
  ds_read_b64_tr_b16 v[110:111], v195 offset:40960
  s_waitcnt lgkmcnt(8)
  v_mfma_f32_16x16x32_bf16 v[120:123], v[64:67], v[88:91], v[120:123]
  v_mfma_f32_16x16x32_bf16 v[124:127], v[64:67], v[92:95], v[124:127]
  v_mfma_f32_16x16x32_bf16 v[152:155], v[68:71], v[88:91], v[152:155]
  v_mfma_f32_16x16x32_bf16 v[156:159], v[68:71], v[92:95], v[156:159]
  ds_read_b64_tr_b16 v[112:113], v196 offset:32768
  ds_read_b64_tr_b16 v[114:115], v197 offset:40960
  ds_read_b64_tr_b16 v[116:117], v198 offset:32768
  ds_read_b64_tr_b16 v[118:119], v199 offset:40960
  s_waitcnt lgkmcnt(8)
  v_mfma_f32_16x16x32_bf16 v[128:131], v[64:67], v[96:99], v[128:131]
  v_mfma_f32_16x16x32_bf16 v[132:135], v[64:67], v[100:103], v[132:135]
  v_mfma_f32_16x16x32_bf16 v[160:163], v[68:71], v[96:99], v[160:163]
  v_mfma_f32_16x16x32_bf16 v[164:167], v[68:71], v[100:103], v[164:167]
  v_add_u32 v184, 0x10000, v184
  v_add_u32 v185, 0x10000, v185
  v_add_u32 v186, 0x10000, v186
  v_add_u32 v187, 0x10000, v187
  v_add_u32 v188, 0x10000, v188
  v_add_u32 v189, 0x10000, v189
  v_add_u32 v190, 0x10000, v190
  v_add_u32 v191, 0x10000, v191
  v_add_u32 v192, 0x10000, v192
  v_add_u32 v193, 0x10000, v193
  v_add_u32 v194, 0x10000, v194
  v_add_u32 v195, 0x10000, v195
  v_add_u32 v196, 0x10000, v196
  v_add_u32 v197, 0x10000, v197
  v_add_u32 v198, 0x10000, v198
  v_add_u32 v199, 0x10000, v199
  ds_read_b64_tr_b16 v[88:89], v184 offset:0
  ds_read_b64_tr_b16 v[90:91], v185 offset:8192
  ds_read_b64_tr_b16 v[92:93], v186 offset:0
  ds_read_b64_tr_b16 v[94:95], v187 offset:8192
  s_waitcnt lgkmcnt(8)
  v_mfma_f32_16x16x32_bf16 v[136:139], v[64:67], v[104:107], v[136:139]
  v_mfma_f32_16x16x32_bf16 v[140:143], v[64:67], v[108:111], v[140:143]
  v_mfma_f32_16x16x32_bf16 v[168:171], v[68:71], v[104:107], v[168:171]
  v_mfma_f32_16x16x32_bf16 v[172:175], v[68:71], v[108:111], v[172:175]
  ds_read_b64_tr_b16 v[96:97], v188 offset:0
  ds_read_b64_tr_b16 v[98:99], v189 offset:8192
  ds_read_b64_tr_b16 v[100:101], v190 offset:0
  ds_read_b64_tr_b16 v[102:103], v191 offset:8192
  s_waitcnt lgkmcnt(8)
  v_mfma_f32_16x16x32_bf16 v[144:147], v[64:67], v[112:115], v[144:147]
  v_mfma_f32_16x16x32_bf16 v[148:151], v[64:67], v[116:119], v[148:151]
  v_mfma_f32_16x16x32_bf16 v[176:179], v[68:71], v[112:115], v[176:179]
  v_mfma_f32_16x16x32_bf16 v[180:183], v[68:71], v[116:119], v[180:183]
  ds_read_b64_tr_b16 v[104:105], v192 offset:0
  ds_read_b64_tr_b16 v[106:107], v193 offset:8192
  ds_read_b64_tr_b16 v[108:109], v194 offset:0
  ds_read_b64_tr_b16 v[110:111], v195 offset:8192
  s_waitcnt lgkmcnt(8)
  v_mfma_f32_16x16x32_bf16 v[120:123], v[72:75], v[88:91], v[120:123]
  v_mfma_f32_16x16x32_bf16 v[124:127], v[72:75], v[92:95], v[124:127]
  v_mfma_f32_16x16x32_bf16 v[152:155], v[76:79], v[88:91], v[152:155]
  v_mfma_f32_16x16x32_bf16 v[156:159], v[76:79], v[92:95], v[156:159]
  ds_read_b64_tr_b16 v[112:113], v196 offset:0
  ds_read_b64_tr_b16 v[114:115], v197 offset:8192
  ds_read_b64_tr_b16 v[116:117], v198 offset:0
  ds_read_b64_tr_b16 v[118:119], v199 offset:8192
  s_waitcnt lgkmcnt(8)
  v_mfma_f32_16x16x32_bf16 v[128:131], v[72:75], v[96:99], v[128:131]
  v_mfma_f32_16x16x32_bf16 v[132:135], v[72:75], v[100:103], v[132:135]
  v_mfma_f32_16x16x32_bf16 v[160:163], v[76:79], v[96:99], v[160:163]
  v_mfma_f32_16x16x32_bf16 v[164:167], v[76:79], v[100:103], v[164:167]
  ds_read_b64_tr_b16 v[88:89], v184 offset:32768
  ds_read_b64_tr_b16 v[90:91], v185 offset:40960
  ds_read_b64_tr_b16 v[92:93], v186 offset:32768
  ds_read_b64_tr_b16 v[94:95], v187 offset:40960
  s_waitcnt lgkmcnt(8)
  v_mfma_f32_16x16x32_bf16 v[136:139], v[72:75], v[104:107], v[136:139]
  v_mfma_f32_16x16x32_bf16 v[140:143], v[72:75], v[108:111], v[140:143]
  v_mfma_f32_16x16x32_bf16 v[168:171], v[76:79], v[104:107], v[168:171]
  v_mfma_f32_16x16x32_bf16 v[172:175], v[76:79], v[108:111], v[172:175]
  ds_read_b64_tr_b16 v[96:97], v188 offset:32768
  ds_read_b64_tr_b16 v[98:99], v189 offset:40960
  ds_read_b64_tr_b16 v[100:101], v190 offset:32768
  ds_read_b64_tr_b16 v[102:103], v191 offset:40960
  s_waitcnt lgkmcnt(8)
  v_mfma_f32_16x16x32_bf16 v[144:147], v[72:75], v[112:115], v[144:147]
  v_mfma_f32_16x16x32_bf16 v[148:151], v[72:75], v[116:119], v[148:151]
  v_mfma_f32_16x16x32_bf16 v[176:179], v[76:79], v[112:115], v[176:179]
  v_mfma_f32_16x16x32_bf16 v[180:183], v[76:79], v[116:119], v[180:183]
  ds_read_b64_tr_b16 v[104:105], v192 offset:32768
  ds_read_b64_tr_b16 v[106:107], v193 offset:40960
  ds_read_b64_tr_b16 v[108:109], v194 offset:32768
  ds_read_b64_tr_b16 v[110:111], v195 offset:40960
  v_add_f32 v8, v8, v9
  v_add_f32 v10, v10, v11
  v_add_f32 v14, v8, v10
  s_waitcnt lgkmcnt(8)
  ds_read_b64_tr_b16 v[112:113], v196 offset:32768
  ds_read_b64_tr_b16 v[114:115], v197 offset:40960
  ds_read_b64_tr_b16 v[116:117], v198 offset:32768
  ds_read_b64_tr_b16 v[118:119], v199 offset:40960
  v_mfma_f32_16x16x32_bf16 v[120:123], v[80:83], v[88:91], v[120:123]
  v_mfma_f32_16x16x32_bf16 v[124:127], v[80:83], v[92:95], v[124:127]
  s_waitcnt lgkmcnt(8)
  v_mfma_f32_16x16x32_bf16 v[128:131], v[80:83], v[96:99], v[128:131]
  v_mfma_f32_16x16x32_bf16 v[132:135], v[80:83], v[100:103], v[132:135]
  s_waitcnt lgkmcnt(4)
  v_mfma_f32_16x16x32_bf16 v[136:139], v[80:83], v[104:107], v[136:139]
  v_mfma_f32_16x16x32_bf16 v[140:143], v[80:83], v[108:111], v[140:143]
  s_waitcnt lgkmcnt(0)
  v_mfma_f32_16x16x32_bf16 v[144:147], v[80:83], v[112:115], v[144:147]
  v_mfma_f32_16x16x32_bf16 v[148:151], v[80:83], v[116:119], v[148:151]
  v_mfma_f32_16x16x32_bf16 v[152:155], v[84:87], v[88:91], v[152:155]
  v_mfma_f32_16x16x32_bf16 v[156:159], v[84:87], v[92:95], v[156:159]
  v_mfma_f32_16x16x32_bf16 v[160:163], v[84:87], v[96:99], v[160:163]
  v_mfma_f32_16x16x32_bf16 v[164:167], v[84:87], v[100:103], v[164:167]
  v_mfma_f32_16x16x32_bf16 v[168:171], v[84:87], v[104:107], v[168:171]
  v_mfma_f32_16x16x32_bf16 v[172:175], v[84:87], v[108:111], v[172:175]
  v_mfma_f32_16x16x32_bf16 v[176:179], v[84:87], v[112:115], v[176:179]
  v_mfma_f32_16x16x32_bf16 v[180:183], v[84:87], v[116:119], v[180:183]
  s_nop 1
  v_cvt_pk_bf16_f32 v200, v120, v124
  v_cvt_pk_bf16_f32 v201, v128, v132
  v_cvt_pk_bf16_f32 v202, v136, v140
  v_cvt_pk_bf16_f32 v203, v144, v148
  s_add_u32 s81, s83, 0
  buffer_store_dwordx4 v[200:203], v216, s[68:71], s81 offen sc1
  v_cvt_pk_bf16_f32 v204, v121, v125
  v_cvt_pk_bf16_f32 v205, v129, v133
  v_cvt_pk_bf16_f32 v206, v137, v141
  v_cvt_pk_bf16_f32 v207, v145, v149
  s_add_u32 s81, s83, 65536
  buffer_store_dwordx4 v[204:207], v216, s[68:71], s81 offen sc1
  v_cvt_pk_bf16_f32 v208, v122, v126
  v_cvt_pk_bf16_f32 v209, v130, v134
  v_cvt_pk_bf16_f32 v210, v138, v142
  v_cvt_pk_bf16_f32 v211, v146, v150
  s_add_u32 s81, s83, 131072
  buffer_store_dwordx4 v[208:211], v216, s[68:71], s81 offen sc1
  v_cvt_pk_bf16_f32 v212, v123, v127
  v_cvt_pk_bf16_f32 v213, v131, v135
  v_cvt_pk_bf16_f32 v214, v139, v143
  v_cvt_pk_bf16_f32 v215, v147, v151
  s_add_u32 s81, s83, 196608
  buffer_store_dwordx4 v[212:215], v216, s[68:71], s81 offen sc1
  s_nop 3
  v_cvt_pk_bf16_f32 v200, v152, v156
  v_cvt_pk_bf16_f32 v201, v160, v164
  v_cvt_pk_bf16_f32 v202, v168, v172
  v_cvt_pk_bf16_f32 v203, v176, v180
  s_add_u32 s81, s83, 1048576
  buffer_store_dwordx4 v[200:203], v216, s[68:71], s81 offen sc1
  v_cvt_pk_bf16_f32 v204, v153, v157
  v_cvt_pk_bf16_f32 v205, v161, v165
  v_cvt_pk_bf16_f32 v206, v169, v173
  v_cvt_pk_bf16_f32 v207, v177, v181
  s_add_u32 s81, s83, 1114112
  buffer_store_dwordx4 v[204:207], v216, s[68:71], s81 offen sc1
  v_cvt_pk_bf16_f32 v208, v154, v158
  v_cvt_pk_bf16_f32 v209, v162, v166
  v_cvt_pk_bf16_f32 v210, v170, v174
  v_cvt_pk_bf16_f32 v211, v178, v182
  s_add_u32 s81, s83, 1179648
  buffer_store_dwordx4 v[208:211], v216, s[68:71], s81 offen sc1
  v_cvt_pk_bf16_f32 v212, v155, v159
  v_cvt_pk_bf16_f32 v213, v163, v167
  v_cvt_pk_bf16_f32 v214, v171, v175
  v_cvt_pk_bf16_f32 v215, v179, v183
  s_add_u32 s81, s83, 1245184
  buffer_store_dwordx4 v[212:215], v216, s[68:71], s81 offen sc1
  s_waitcnt vmcnt(0)
  s_barrier
  s_cmp_ge_u32 s3, 2
  s_cbranch_scc1 L_AA_j1
  s_cmp_lg_u32 s3, 0
  s_cbranch_scc1 L_AA_nostat
  v_mov_b32 v8, v12
  v_mov_b32 v9, v14
  v_mov_b32 v10, s72
  v_mov_b32 v11, s73
  s_lshl_b32 s80, s100, 9
  s_add_u32 s80, s80, 0xb0000
  s_mov_b64 exec, s[94:95]
  buffer_store_dwordx4 v[8:11], v15, s[68:71], s80 offen sc1
  s_mov_b64 exec, -1
L_AA_nostat:
  s_lshl_b32 s80, s98, 4
  s_lshl_b32 s81, s3, 15
  s_add_u32 s80, s80, s81
  s_add_u32 s80, s80, 0xb0000
  v_lshlrev_b32 v5, 9, v0
  s_mov_b32 s75, 0
L_poll_astat_12:
  buffer_load_dwordx4 v[16:19], v5, s[68:71], s80 offen offset:0 sc1
  s_waitcnt vmcnt(0)
  v_cmp_eq_u64 vcc, s[72:73], v[18:19]
  s_cmp_eq_u64 vcc, exec
  s_cbranch_scc1 L_pdone_astat_13
  s_add_u32 s75, s75, 1
  s_cmp_lt_u32 s75, 400000
  s_cbranch_scc1 L_poll_astat_12
L_pdone_astat_13:
L_AA_j1:
  s_barrier
  v_lshlrev_b32 v5, 1, v1
  v_xor_b32 v6, v5, v2
  v_lshlrev_b32 v6, 4, v6
  v_mul_u32_u24 v5, 1024, v1
  v_add_u32 v8, v5, v6
  v_xor_b32 v9, 0x80, v8
  s_lshr_b32 s76, s3, 1
  s_lshl_b32 s76, s76, 5
  s_add_u32 s76, s76, s98
  s_lshl_b32 s76, s76, 16
  s_and_b32 s77, s3, 1
  s_lshl_b32 s77, s77, 15
  s_add_u32 s76, s76, s77
  s_lshl_b32 s77, s99, 8
  s_add_u32 s76, s76, s77
  s_add_u32 s76, s76, 0x400000
  s_lshl_b32 s77, s3, 13
  s_add_u32 s77, s77, 65536
  s_add_u32 m0, s77, 0
  s_add_u32 s88, s76, 0
  buffer_load_dwordx4 v8, s[68:71], s88 offen sc1 lds
  s_add_u32 m0, s77, 1024
  s_add_u32 s88, s76, 4096
  buffer_load_dwordx4 v8, s[68:71], s88 offen sc1 lds
  s_add_u32 m0, s77, 2048
  s_add_u32 s88, s76, 8192
  buffer_load_dwordx4 v9, s[68:71], s88 offen sc1 lds
  s_add_u32 m0, s77, 3072
  s_add_u32 s88, s76, 12288
  buffer_load_dwordx4 v9, s[68:71], s88 offen sc1 lds
  s_add_u32 m0, s77, 4096
  s_add_u32 s88, s76, 16384
  buffer_load_dwordx4 v8, s[68:71], s88 offen sc1 lds
  s_add_u32 m0, s77, 5120
  s_add_u32 s88, s76, 20480
  buffer_load_dwordx4 v8, s[68:71], s88 offen sc1 lds
  s_add_u32 m0, s77, 6144
  s_add_u32 s88, s76, 24576
  buffer_load_dwordx4 v9, s[68:71], s88 offen sc1 lds
  s_add_u32 m0, s77, 7168
  s_add_u32 s88, s76, 28672
  buffer_load_dwordx4 v9, s[68:71], s88 offen sc1 lds
  s_cmp_ge_u32 s3, 2
  s_cbranch_scc1 L_AA_j2
  v_mov_b32 v6, v16
  s_nop 1
  v_max_f32_dpp v6, v6, v6 row_ror:8 row_mask:0xf bank_mask:0xf
  s_nop 1
  v_max_f32_dpp v6, v6, v6 row_ror:4 row_mask:0xf bank_mask:0xf
  s_nop 1
  v_max_f32_dpp v6, v6, v6 row_ror:2 row_mask:0xf bank_mask:0xf
  s_nop 1
  v_max_f32_dpp v6, v6, v6 row_ror:1 row_mask:0xf bank_mask:0xf
  v_mov_b32 v7, v6
  s_nop 1
  v_permlane16_swap_b32 v6, v7
  s_nop 0
  v_max_f32 v6, v6, v7
  v_mov_b32 v7, v6
  s_nop 1
  v_permlane32_swap_b32 v6, v7
  s_nop 0
  v_max_f32 v6, v6, v7
  v_sub_f32 v5, v16, v6
  v_exp_f32 v5, v5
  s_nop 0
  v_mul_f32 v6, v5, v17
  s_nop 1
  v_add_f32_dpp v6, v6, v6 row_ror:8 row_mask:0xf bank_mask:0xf
  s_nop 1
  v_add_f32_dpp v6, v6, v6 row_ror:4 row_mask:0xf bank_mask:0xf
  s_nop 1
  v_add_f32_dpp v6, v6, v6 row_ror:2 row_mask:0xf bank_mask:0xf
  s_nop 1
  v_add_f32_dpp v6, v6, v6 row_ror:1 row_mask:0xf bank_mask:0xf
  v_mov_b32 v7, v6
  s_nop 1
  v_permlane16_swap_b32 v6, v7
  s_nop 0
  v_add_f32 v6, v6, v7
  v_mov_b32 v7, v6
  s_nop 1
  v_permlane32_swap_b32 v6, v7
  s_nop 0
  v_add_f32 v6, v6, v7
  v_rcp_f32 v6, v6
  s_nop 0
  v_mul_f32 v5, v5, v6
  v_cvt_pk_bf16_f32 v6, v5, v5
  v_lshlrev_b32 v7, 16, v6
  v_sub_f32 v7, v5, v7
  v_cvt_pk_bf16_f32 v7, v7, v7
  s_lshl_b32 s80, s3, 8
  s_add_u32 s80, s80, 141312
  v_lshl_add_u32 v5, v0, 1, s80
  ds_write_b16 v5, v6
  ds_write_b16 v5, v7 offset:128
L_AA_j2:
  v_and_b32 v6, 1, v1
  v_lshl_or_b32 v6, v6, 2, v3
  v_lshlrev_b32 v6, 1, v6
  v_lshrrev_b32 v7, 1, v4
  v_xor_b32 v7, v7, v6
  v_lshlrev_b32 v7, 4, v7
  v_lshl_add_u32 v6, v1, 3, v3
  v_lshl_add_u32 v7, v6, 8, v7
  v_and_b32 v6, 1, v4
  v_lshl_add_u32 v120, v6, 3, v7
  s_lshl_b32 s89, s3, 6
  v_xor_b32 v120, s89, v120
  v_xor_b32 v121, 32, v120
  v_add_u32 v76, 0x10000, v120
  v_add_u32 v77, 0x10000, v121
  v_add_u32 v122, 0x8000, v120
  v_add_u32 v123, 0x8000, v121
  v_and_b32 v5, 1, v0
  v_lshlrev_b32 v6, 7, v5
  v_lshl_add_u32 v6, v1, 4, v6
  v_add_u32 v124, 0x22800, v6
  v_lshlrev_b32 v6, 8, v5
  v_lshl_add_u32 v6, v1, 4, v6
  v_add_u32 v126, 0x22c00, v6
  v_add_u32 v127, 0x23000, v6
  v_and_b32 v5, 7, v2
  v_lshlrev_b32 v5, 4, v5
  v_lshrrev_b32 v6, 3, v2
  v_add_u32 v5, v5, v6
  s_lshl_b32 s80, s3, 2
  v_add_u32 v5, s80, v5
  v_lshlrev_b32 v5, 1, v5
  v_add_u32 v125, 0x22c00, v5
  s_lshl_b32 s82, s98, 2
  s_add_u32 s82, s82, s99
  s_lshl_b32 s82, s82, 11
  s_lshl_b32 s81, s3, 9
  s_add_u32 s82, s82, s81
  s_add_u32 s82, s82, 0xc0000
  s_waitcnt vmcnt(0) lgkmcnt(0)
  s_barrier
  ds_read_b128 v[16:19], v124 offset:0
  ds_read_b128 v[20:23], v124 offset:64
  ds_read_b128 v[24:27], v124 offset:256
  ds_read_b128 v[28:31], v124 offset:320
  ds_read_b64_tr_b16 v[32:33], v76 offset:0
  ds_read_b64_tr_b16 v[34:35], v76 offset:1024
  ds_read_b64_tr_b16 v[36:37], v77 offset:0
  ds_read_b64_tr_b16 v[38:39], v77 offset:1024
  ds_read_b64_tr_b16 v[40:41], v76 offset:8192
  ds_read_b64_tr_b16 v[42:43], v76 offset:9216
  ds_read_b64_tr_b16 v[44:45], v77 offset:8192
  ds_read_b64_tr_b16 v[46:47], v77 offset:9216
  s_waitcnt lgkmcnt(4)
  v_mfma_f32_16x16x32_bf16 v[64:67], v[16:19], v[32:35], 0
  v_mfma_f32_16x16x32_bf16 v[68:71], v[16:19], v[36:39], 0
  ds_read_b64_tr_b16 v[48:49], v76 offset:16384
  ds_read_b64_tr_b16 v[50:51], v76 offset:17408
  ds_read_b64_tr_b16 v[52:53], v77 offset:16384
  ds_read_b64_tr_b16 v[54:55], v77 offset:17408
  s_waitcnt lgkmcnt(4)
  v_mfma_f32_16x16x32_bf16 v[64:67], v[20:23], v[40:43], v[64:67]
  v_mfma_f32_16x16x32_bf16 v[68:71], v[20:23], v[44:47], v[68:71]
  ds_read_b64_tr_b16 v[56:57], v76 offset:24576
  ds_read_b64_tr_b16 v[58:59], v76 offset:25600
  ds_read_b64_tr_b16 v[60:61], v77 offset:24576
  ds_read_b64_tr_b16 v[62:63], v77 offset:25600
  s_waitcnt lgkmcnt(4)
  v_mfma_f32_16x16x32_bf16 v[80:83], v[24:27], v[48:51], 0
  v_mfma_f32_16x16x32_bf16 v[84:87], v[24:27], v[52:55], 0
  ds_read_b64_tr_b16 v[128:129], v120 offset:0
  ds_read_b64_tr_b16 v[130:131], v120 offset:1024
  ds_read_b64_tr_b16 v[132:133], v121 offset:0
  ds_read_b64_tr_b16 v[134:135], v121 offset:1024
  s_waitcnt lgkmcnt(4)
  v_mfma_f32_16x16x32_bf16 v[80:83], v[28:31], v[56:59], v[80:83]
  v_mfma_f32_16x16x32_bf16 v[84:87], v[28:31], v[60:63], v[84:87]
  ds_read_b64_tr_b16 v[136:137], v120 offset:8192
  ds_read_b64_tr_b16 v[138:139], v120 offset:9216
  ds_read_b64_tr_b16 v[140:141], v121 offset:8192
  ds_read_b64_tr_b16 v[142:143], v121 offset:9216
  v_add_f32 v64, v64, v65
  v_add_f32 v68, v68, v69
  v_cvt_pk_bf16_f32 v64, v64, v68
  ds_write_b16 v125, v64
  ds_write_b16_d16_hi v125, v64 offset:4
  s_nop 1
  v_add_f32 v80, v80, v81
  v_add_f32 v84, v84, v85
  v_cvt_pk_bf16_f32 v80, v80, v84
  ds_write_b16 v125, v80 offset:256
  ds_write_b16_d16_hi v125, v80 offset:260
  s_waitcnt lgkmcnt(0)
  s_barrier
  ds_read_b128 v[16:19], v126 offset:0
  ds_read_b128 v[20:23], v126 offset:64
  ds_read_b128 v[24:27], v126 offset:128
  ds_read_b128 v[28:31], v126 offset:192
  ds_read_b64_tr_b16 v[144:145], v120 offset:16384
  ds_read_b64_tr_b16 v[146:147], v120 offset:17408
  ds_read_b64_tr_b16 v[148:149], v121 offset:16384
  ds_read_b64_tr_b16 v[150:151], v121 offset:17408
  ds_read_b64_tr_b16 v[152:153], v120 offset:24576
  ds_read_b64_tr_b16 v[154:155], v120 offset:25600
  ds_read_b64_tr_b16 v[156:157], v121 offset:24576
  ds_read_b64_tr_b16 v[158:159], v121 offset:25600
  s_waitcnt lgkmcnt(8)
  v_mfma_f32_16x16x32_bf16 v[64:67], v[16:19], v[128:131], 0
  v_mfma_f32_16x16x32_bf16 v[68:71], v[16:19], v[132:135], 0
  v_mfma_f32_16x16x32_bf16 v[64:67], v[20:23], v[136:139], v[64:67]
  v_mfma_f32_16x16x32_bf16 v[68:71], v[20:23], v[140:143], v[68:71]
  s_waitcnt lgkmcnt(4)
  v_mfma_f32_16x16x32_bf16 v[64:67], v[24:27], v[144:147], v[64:67]
  v_mfma_f32_16x16x32_bf16 v[68:71], v[24:27], v[148:151], v[68:71]
  s_waitcnt lgkmcnt(0)
  v_mfma_f32_16x16x32_bf16 v[64:67], v[28:31], v[152:155], v[64:67]
  v_mfma_f32_16x16x32_bf16 v[68:71], v[28:31], v[156:159], v[68:71]
  ds_read_b64_tr_b16 v[160:161], v122 offset:0
  ds_read_b64_tr_b16 v[162:163], v122 offset:1024
  ds_read_b64_tr_b16 v[164:165], v123 offset:0
  ds_read_b64_tr_b16 v[166:167], v123 offset:1024
  ds_read_b64_tr_b16 v[168:169], v122 offset:8192
  ds_read_b64_tr_b16 v[170:171], v122 offset:9216
  ds_read_b64_tr_b16 v[172:173], v123 offset:8192
  ds_read_b64_tr_b16 v[174:175], v123 offset:9216
  ds_read_b64_tr_b16 v[176:177], v122 offset:16384
  ds_read_b64_tr_b16 v[178:179], v122 offset:17408
  ds_read_b64_tr_b16 v[180:181], v123 offset:16384
  ds_read_b64_tr_b16 v[182:183], v123 offset:17408
  v_cndmask_b32 v72, v68, v64, s[92:93]
  v_cndmask_b32 v73, v69, v65, s[92:93]
  v_mov_b32 v74, s72
  v_mov_b32 v75, s73
  s_mov_b64 exec, s[94:95]
  buffer_store_dwordx4 v[72:75], v15, s[68:71], s82 offen
  s_mov_b64 exec, -1
  s_lshl_b32 s80, s98, 13
  s_add_u32 s80, s80, 0xc0000
  v_lshrrev_b32 v88, 5, v0
  v_and_b32 v89, 31, v0
  v_lshlrev_b32 v90, 4, v89
  v_lshl_add_u32 v88, v88, 11, v90
  s_lshl_b32 s86, s3, 9
  s_add_u32 s86, s86, s80
  s_add_u32 s87, s86, 4096
  s_mov_b32 s75, 0
L_poll_ctx_14:
  buffer_load_dwordx4 v[80:83], v88, s[68:71], s86 offen offset:0 sc1
  buffer_load_dwordx4 v[84:87], v88, s[68:71], s87 offen offset:0 sc1
  s_waitcnt vmcnt(0)
  v_cmp_eq_u64 vcc, s[72:73], v[82:83]
  v_cmp_eq_u64 s[96:97], s[72:73], v[86:87]
  s_and_b64 vcc, vcc, s[96:97]
  s_cmp_eq_u64 vcc, exec
  s_cbranch_scc1 L_pdone_ctx_15
  s_add_u32 s75, s75, 1
  s_cmp_lt_u32 s75, 64
  s_cbranch_scc1 L_poll_ctx_14
  s_cmp_lg_u32 s75, 64
  s_cbranch_scc1 L_pfb_16
  s_mov_b64 exec, s[94:95]
  s_xor_b32 s89, s82, 0x2000000
  buffer_store_dwordx4 v[72:75], v15, s[68:71], s89 offen sc1
  s_mov_b64 exec, -1
L_pfb_16:
  s_xor_b32 s86, s86, 0x2000000
  s_xor_b32 s87, s87, 0x2000000
  s_cmp_lt_u32 s75, 400000
  s_cbranch_scc1 L_poll_ctx_14
L_pdone_ctx_15:
  s_mov_b64 exec, s[94:95]
  s_xor_b32 s89, s82, 0x2000000
  buffer_store_dwordx4 v[72:75], v15, s[68:71], s89 offen sc1
  s_mov_b64 exec, -1
  v_add_f32 v80, v80, v84
  v_add_f32 v81, v81, v85
  v_mov_b32 v82, v80
  v_mov_b32 v83, v81
  s_nop 0
  v_permlane32_swap_b32 v80, v82
  v_permlane32_swap_b32 v81, v83
  s_nop 0
  v_add_f32 v80, v80, v82
  v_add_f32 v81, v81, v83
  v_cvt_pk_bf16_f32 v80, v80, v81
  s_lshl_b32 s86, s3, 6
  s_add_u32 s86, s86, 0x23000
  v_lshl_add_u32 v88, v89, 1, s86
  ds_write_b16 v88, v80
  ds_write_b16_d16_hi v88, v80 offset:256
  s_waitcnt lgkmcnt(8)
  ds_read_b64_tr_b16 v[184:185], v122 offset:24576
  ds_read_b64_tr_b16 v[186:187], v122 offset:25600
  ds_read_b64_tr_b16 v[188:189], v123 offset:24576
  ds_read_b64_tr_b16 v[190:191], v123 offset:25600
  s_lshl_b32 s80, s99, 3
  s_lshl_b32 s81, s3, 1
  s_add_u32 s80, s80, s81
  s_lshl_b32 s80, s80, 13
  s_lshl_b32 s81, s98, 8
  s_add_u32 s80, s80, s81
  s_add_u32 s80, s80, 0x100000
  v_lshlrev_b32 v5, 13, v1
  v_lshl_add_u32 v5, v2, 4, v5
  s_waitcnt lgkmcnt(0)
  s_barrier
  ds_read_b128 v[16:19], v127 offset:0
  ds_read_b128 v[20:23], v127 offset:64
  ds_read_b128 v[24:27], v127 offset:128
  ds_read_b128 v[28:31], v127 offset:192
  s_waitcnt lgkmcnt(3)
  v_mfma_f32_16x16x32_bf16 v[64:67], v[16:19], v[160:163], 0
  v_mfma_f32_16x16x32_bf16 v[68:71], v[16:19], v[164:167], 0
  s_waitcnt lgkmcnt(2)
  v_mfma_f32_16x16x32_bf16 v[64:67], v[20:23], v[168:171], v[64:67]
  v_mfma_f32_16x16x32_bf16 v[68:71], v[20:23], v[172:175], v[68:71]
  s_waitcnt lgkmcnt(1)
  v_mfma_f32_16x16x32_bf16 v[64:67], v[24:27], v[176:179], v[64:67]
  v_mfma_f32_16x16x32_bf16 v[68:71], v[24:27], v[180:183], v[68:71]
  s_waitcnt lgkmcnt(0)
  v_mfma_f32_16x16x32_bf16 v[64:67], v[28:31], v[184:187], v[64:67]
  v_mfma_f32_16x16x32_bf16 v[68:71], v[28:31], v[188:191], v[68:71]
  s_nop 8
  v_cndmask_b32 v72, v68, v64, s[92:93]
  v_cndmask_b32 v73, v69, v65, s[92:93]
  v_mov_b32 v74, s72
  v_mov_b32 v75, s73
  s_mov_b64 exec, s[94:95]
  buffer_store_dwordx4 v[72:75], v5, s[68:71], s80 offen sc1
  s_mov_b64 exec, -1
  s_cmp_ge_u32 s100, 32
  s_cbranch_scc1 L_AA_fin
  s_cmp_lg_u32 s3, 0
  s_cbranch_scc1 L_AA_fin
  v_lshlrev_b32 v8, 4, v0
  s_lshl_b32 s76, s100, 13
  s_add_u32 s76, s76, 0x100000
  s_add_u32 s77, s76, 4096
  s_mov_b32 s75, 0
L_poll_fr0_17:
  buffer_load_dwordx4 v[12:15], v8, s[68:71], s76 offen offset:0 sc1
  buffer_load_dwordx4 v[16:19], v8, s[68:71], s76 offen offset:1024 sc1
  buffer_load_dwordx4 v[20:23], v8, s[68:71], s76 offen offset:2048 sc1
  buffer_load_dwordx4 v[24:27], v8, s[68:71], s76 offen offset:3072 sc1
  buffer_load_dwordx4 v[28:31], v8, s[68:71], s77 offen offset:0 sc1
  buffer_load_dwordx4 v[32:35], v8, s[68:71], s77 offen offset:1024 sc1
  buffer_load_dwordx4 v[36:39], v8, s[68:71], s77 offen offset:2048 sc1
  buffer_load_dwordx4 v[40:43], v8, s[68:71], s77 offen offset:3072 sc1
  s_waitcnt vmcnt(0)
  v_cmp_eq_u64 vcc, s[72:73], v[14:15]
  v_cmp_eq_u64 s[96:97], s[72:73], v[18:19]
  s_and_b64 vcc, vcc, s[96:97]
  v_cmp_eq_u64 s[96:97], s[72:73], v[22:23]
  s_and_b64 vcc, vcc, s[96:97]
  v_cmp_eq_u64 s[96:97], s[72:73], v[26:27]
  s_and_b64 vcc, vcc, s[96:97]
  v_cmp_eq_u64 s[96:97], s[72:73], v[30:31]
  s_and_b64 vcc, vcc, s[96:97]
  v_cmp_eq_u64 s[96:97], s[72:73], v[34:35]
  s_and_b64 vcc, vcc, s[96:97]
  v_cmp_eq_u64 s[96:97], s[72:73], v[38:39]
  s_and_b64 vcc, vcc, s[96:97]
  v_cmp_eq_u64 s[96:97], s[72:73], v[42:43]
  s_and_b64 vcc, vcc, s[96:97]
  s_cmp_eq_u64 vcc, exec
  s_cbranch_scc1 L_pdone_fr0_18
  s_add_u32 s75, s75, 1
  s_cmp_lt_u32 s75, 400000
  s_cbranch_scc1 L_poll_fr0_17
L_pdone_fr0_18:
  v_add_f32 v12, v12, v16
  v_add_f32 v20, v20, v24
  v_add_f32 v28, v28, v32
  v_add_f32 v36, v36, v40
  v_add_f32 v13, v13, v17
  v_add_f32 v21, v21, v25
  v_add_f32 v29, v29, v33
  v_add_f32 v37, v37, v41
  v_add_f32 v12, v12, v20
  v_add_f32 v28, v28, v36
  v_add_f32 v13, v13, v21
  v_add_f32 v29, v29, v37
  v_add_f32 v12, v12, v28
  v_add_f32 v13, v13, v29
  v_mov_b32 v14, v12
  v_mov_b32 v15, v13
  s_nop 0
  v_permlane32_swap_b32 v12, v14
  v_permlane32_swap_b32 v13, v15
  s_nop 0
  v_add_f32 v12, v12, v14
  v_add_f32 v13, v13, v15
  v_mov_b32 v14, v12
  v_mov_b32 v15, v13
  s_nop 0
  v_permlane16_swap_b32 v12, v14
  v_permlane16_swap_b32 v13, v15
  s_nop 0
  v_add_f32 v12, v12, v14
  v_add_f32 v13, v13, v15
  v_cvt_pk_bf16_f32 v12, v12, v13
  s_mov_b32 s64, s38
  s_and_b32 s65, s39, 0xffff
  s_mov_b32 s66, 0x1000
  s_mov_b32 s67, 0x20000
  v_lshlrev_b32 v8, 1, v2
  s_lshl_b32 s76, s100, 5
  s_add_u32 s76, s76, 0
  s_add_u32 s77, s76, 2048
  s_mov_b64 exec, s[92:93]
  buffer_store_short v12, v8, s[64:67], s76 offen
  buffer_store_short_d16_hi v12, v8, s[64:67], s77 offen
  s_mov_b64 exec, -1
  s_cmp_lg_u32 s100, 0
  s_cbranch_scc1 L_AA_fin
  v_mov_b32 v8, s72
  v_mov_b32 v5, 0
  s_mov_b64 exec, 1
  buffer_store_dword v8, v5, s[68:71], 0 offen offset:0
  s_mov_b64 exec, -1
L_AA_fin:
  s_endpgm
L_AB_load:
  s_setprio 0
  s_and_b32 s84, s2, 7
  s_bfe_u32 s85, s2, 0x40003
  s_lshr_b32 s98, s85, 2
  s_lshl_b32 s84, s84, 2
  s_add_u32 s98, s98, s84
  s_and_b32 s99, s85, 3
  s_and_b32 s84, s2, 7
  s_bfe_u32 s85, s2, 0x40003
  s_lshr_b32 s100, s85, 3
  s_lshl_b32 s100, s100, 3
  s_add_u32 s100, s100, s84
  s_lshl_b32 s100, s100, 3
  s_and_b32 s85, s85, 7
  s_add_u32 s100, s100, s85
  s_sub_u32 s101, s3, 4
  s_lshr_b32 s76, s100, 3
  s_lshl_b32 s76, s76, 21
  s_and_b32 s77, s100, 7
  s_lshl_b32 s77, s77, 16
  s_add_u32 s76, s76, s77
  s_add_u32 s76, s76, 0x180000
  s_lshl_b32 s77, s101, 14
  s_add_u32 s76, s76, s77
  s_add_u32 s78, s77, 65536
  v_xor_b32 v6, v1, v2
  v_lshlrev_b32 v6, 4, v6
  v_mul_u32_u24 v5, 256, v1
  v_add_u32 v8, v5, v6
  v_xor_b32 v9, 0x40, v8
  v_xor_b32 v10, 0x80, v8
  v_xor_b32 v11, 0xc0, v8
  v_lshlrev_b32 v5, 1, v1
  v_xor_b32 v5, v5, v2
  v_lshlrev_b32 v5, 4, v5
  v_lshl_add_u32 v12, v1, 8, v5
  v_xor_b32 v13, 0x80, v12
  v_lshlrev_b32 v5, 1, v1
  v_xor_b32 v6, v5, v2
  v_lshlrev_b32 v6, 4, v6
  v_mul_u32_u24 v5, 1024, v1
  v_add_u32 v14, v5, v6
  v_xor_b32 v15, 0x80, v14
  s_lshl_b32 s80, s98, 17
  s_lshl_b32 s81, s99, 8
  s_add_u32 s80, s80, s81
  s_lshl_b32 s81, s101, 15
  s_add_u32 s80, s80, s81
  s_waitcnt lgkmcnt(0)
  s_mov_b32 s56, s30
  s_and_b32 s57, s31, 0xffff
  s_mov_b32 s58, 0x2000000
  s_mov_b32 s59, 0x20000
  s_mov_b32 s60, s32
  s_and_b32 s61, s33, 0xffff
  s_mov_b32 s62, 0x2000000
  s_mov_b32 s63, 0x20000
  s_mov_b32 s52, s36
  s_and_b32 s53, s37, 0xffff
  s_mov_b32 s54, 0x400000
  s_mov_b32 s55, 0x20000
  s_mov_b32 s68, s42
  s_and_b32 s69, s43, 0xffff
  s_mov_b32 s70, 0x10000000
  s_mov_b32 s71, 0x20000
  s_load_dword s74, s[42:43], 0x0
  s_waitcnt lgkmcnt(0)
  s_mul_i32 s72, s74, 1664525
  s_add_u32 s72, s72, 1013904223
  s_xor_b32 s73, s72, 0x5bd1e995
  s_barrier
  s_barrier
  s_barrier
  s_cmp_ge_u32 s101, 2
  s_cbranch_scc1 L_ld1e
  s_add_u32 m0, s77, 0
  s_add_u32 s79, s76, 0
  buffer_load_dwordx4 v8, s[56:59], s79 offen offset:0 nt lds
  buffer_load_dwordx4 v9, s[56:59], s79 offen offset:1024 nt lds
  buffer_load_dwordx4 v10, s[56:59], s79 offen offset:2048 nt lds
  buffer_load_dwordx4 v11, s[56:59], s79 offen offset:3072 nt lds
  s_add_u32 m0, s77, 4096
  s_add_u32 s79, s76, 4096
  buffer_load_dwordx4 v8, s[56:59], s79 offen offset:0 nt lds
  buffer_load_dwordx4 v9, s[56:59], s79 offen offset:1024 nt lds
  buffer_load_dwordx4 v10, s[56:59], s79 offen offset:2048 nt lds
  buffer_load_dwordx4 v11, s[56:59], s79 offen offset:3072 nt lds
  s_branch L_lde
L_ld1e:
  s_add_u32 m0, s78, 0
  s_add_u32 s79, s76, 0
  buffer_load_dwordx4 v12, s[60:63], s79 offen offset:0 nt lds
  buffer_load_dwordx4 v13, s[60:63], s79 offen offset:1024 nt lds
  buffer_load_dwordx4 v12, s[60:63], s79 offen offset:2048 nt lds
  buffer_load_dwordx4 v13, s[60:63], s79 offen offset:3072 nt lds
  s_add_u32 m0, s78, 4096
  s_add_u32 s79, s76, 4096
  buffer_load_dwordx4 v12, s[60:63], s79 offen offset:0 nt lds
  buffer_load_dwordx4 v13, s[60:63], s79 offen offset:1024 nt lds
  buffer_load_dwordx4 v12, s[60:63], s79 offen offset:2048 nt lds
  buffer_load_dwordx4 v13, s[60:63], s79 offen offset:3072 nt lds
L_lde:
  s_barrier
  s_barrier
  s_cmp_ge_u32 s101, 2
  s_cbranch_scc1 L_ld1r
  s_add_u32 m0, s77, 8192
  s_add_u32 s79, s76, 8192
  buffer_load_dwordx4 v8, s[56:59], s79 offen offset:0 nt lds
  buffer_load_dwordx4 v9, s[56:59], s79 offen offset:1024 nt lds
  buffer_load_dwordx4 v10, s[56:59], s79 offen offset:2048 nt lds
  buffer_load_dwordx4 v11, s[56:59], s79 offen offset:3072 nt lds
  s_add_u32 m0, s77, 12288
  s_add_u32 s79, s76, 12288
  buffer_load_dwordx4 v8, s[56:59], s79 offen offset:0 nt lds
  buffer_load_dwordx4 v9, s[56:59], s79 offen offset:1024 nt lds
  buffer_load_dwordx4 v10, s[56:59], s79 offen offset:2048 nt lds
  buffer_load_dwordx4 v11, s[56:59], s79 offen offset:3072 nt lds
  s_add_u32 m0, s78, 0
  s_add_u32 s79, s76, 0
  buffer_load_dwordx4 v12, s[60:63], s79 offen offset:0 nt lds
  buffer_load_dwordx4 v13, s[60:63], s79 offen offset:1024 nt lds
  buffer_load_dwordx4 v12, s[60:63], s79 offen offset:2048 nt lds
  buffer_load_dwordx4 v13, s[60:63], s79 offen offset:3072 nt lds
  s_add_u32 m0, s78, 4096
  s_add_u32 s79, s76, 4096
  buffer_load_dwordx4 v12, s[60:63], s79 offen offset:0 nt lds
  buffer_load_dwordx4 v13, s[60:63], s79 offen offset:1024 nt lds
  buffer_load_dwordx4 v12, s[60:63], s79 offen offset:2048 nt lds
  buffer_load_dwordx4 v13, s[60:63], s79 offen offset:3072 nt lds
  s_add_u32 m0, s78, 8192
  s_add_u32 s79, s76, 8192
  buffer_load_dwordx4 v12, s[60:63], s79 offen offset:0 nt lds
  buffer_load_dwordx4 v13, s[60:63], s79 offen offset:1024 nt lds
  buffer_load_dwordx4 v12, s[60:63], s79 offen offset:2048 nt lds
  buffer_load_dwordx4 v13, s[60:63], s79 offen offset:3072 nt lds
  s_add_u32 m0, s78, 12288
  s_add_u32 s79, s76, 12288
  buffer_load_dwordx4 v12, s[60:63], s79 offen offset:0 nt lds
  buffer_load_dwordx4 v13, s[60:63], s79 offen offset:1024 nt lds
  buffer_load_dwordx4 v12, s[60:63], s79 offen offset:2048 nt lds
  buffer_load_dwordx4 v13, s[60:63], s79 offen offset:3072 nt lds
  s_waitcnt vmcnt(23)
  s_waitcnt vmcnt(16)
  s_barrier
  s_barrier
  s_add_u32 m0, s77, 0
  s_add_u32 s79, s80, 0
  buffer_load_dwordx4 v14, s[52:55], s79 offen nt lds
  s_waitcnt vmcnt(23)
  s_add_u32 m0, s77, 1024
  s_add_u32 s79, s80, 4096
  buffer_load_dwordx4 v14, s[52:55], s79 offen nt lds
  s_waitcnt vmcnt(23)
  s_add_u32 m0, s77, 2048
  s_add_u32 s79, s80, 8192
  buffer_load_dwordx4 v15, s[52:55], s79 offen nt lds
  s_waitcnt vmcnt(23)
  s_add_u32 m0, s77, 3072
  s_add_u32 s79, s80, 12288
  buffer_load_dwordx4 v15, s[52:55], s79 offen nt lds
  s_waitcnt vmcnt(23)
  s_add_u32 m0, s77, 4096
  s_add_u32 s79, s80, 16384
  buffer_load_dwordx4 v14, s[52:55], s79 offen nt lds
  s_waitcnt vmcnt(23)
  s_add_u32 m0, s77, 5120
  s_add_u32 s79, s80, 20480
  buffer_load_dwordx4 v14, s[52:55], s79 offen nt lds
  s_waitcnt vmcnt(23)
  s_add_u32 m0, s77, 6144
  s_add_u32 s79, s80, 24576
  buffer_load_dwordx4 v15, s[52:55], s79 offen nt lds
  s_waitcnt vmcnt(23)
  s_add_u32 m0, s77, 7168
  s_add_u32 s79, s80, 28672
  buffer_load_dwordx4 v15, s[52:55], s79 offen nt lds
  s_waitcnt vmcnt(8)
  s_barrier
  s_branch L_ldr
L_ld1r:
  s_add_u32 m0, s77, 0
  s_add_u32 s79, s76, 0
  buffer_load_dwordx4 v8, s[56:59], s79 offen offset:0 nt lds
  buffer_load_dwordx4 v9, s[56:59], s79 offen offset:1024 nt lds
  buffer_load_dwordx4 v10, s[56:59], s79 offen offset:2048 nt lds
  buffer_load_dwordx4 v11, s[56:59], s79 offen offset:3072 nt lds
  s_add_u32 m0, s77, 4096
  s_add_u32 s79, s76, 4096
  buffer_load_dwordx4 v8, s[56:59], s79 offen offset:0 nt lds
  buffer_load_dwordx4 v9, s[56:59], s79 offen offset:1024 nt lds
  buffer_load_dwordx4 v10, s[56:59], s79 offen offset:2048 nt lds
  buffer_load_dwordx4 v11, s[56:59], s79 offen offset:3072 nt lds
  s_add_u32 m0, s77, 8192
  s_add_u32 s79, s76, 8192
  buffer_load_dwordx4 v8, s[56:59], s79 offen offset:0 nt lds
  buffer_load_dwordx4 v9, s[56:59], s79 offen offset:1024 nt lds
  buffer_load_dwordx4 v10, s[56:59], s79 offen offset:2048 nt lds
  buffer_load_dwordx4 v11, s[56:59], s79 offen offset:3072 nt lds
  s_add_u32 m0, s77, 12288
  s_add_u32 s79, s76, 12288
  buffer_load_dwordx4 v8, s[56:59], s79 offen offset:0 nt lds
  buffer_load_dwordx4 v9, s[56:59], s79 offen offset:1024 nt lds
  buffer_load_dwordx4 v10, s[56:59], s79 offen offset:2048 nt lds
  buffer_load_dwordx4 v11, s[56:59], s79 offen offset:3072 nt lds
  s_add_u32 m0, s78, 8192
  s_add_u32 s79, s76, 8192
  buffer_load_dwordx4 v12, s[60:63], s79 offen offset:0 nt lds
  buffer_load_dwordx4 v13, s[60:63], s79 offen offset:1024 nt lds
  buffer_load_dwordx4 v12, s[60:63], s79 offen offset:2048 nt lds
  buffer_load_dwordx4 v13, s[60:63], s79 offen offset:3072 nt lds
  s_add_u32 m0, s78, 12288
  s_add_u32 s79, s76, 12288
  buffer_load_dwordx4 v12, s[60:63], s79 offen offset:0 nt lds
  buffer_load_dwordx4 v13, s[60:63], s79 offen offset:1024 nt lds
  buffer_load_dwordx4 v12, s[60:63], s79 offen offset:2048 nt lds
  buffer_load_dwordx4 v13, s[60:63], s79 offen offset:3072 nt lds
  s_waitcnt vmcnt(23)
  s_waitcnt vmcnt(8)
  s_barrier
  s_barrier
  s_add_u32 m0, s77, 0
  s_add_u32 s79, s80, 0
  buffer_load_dwordx4 v14, s[52:55], s79 offen nt lds
  s_waitcnt vmcnt(23)
  s_add_u32 m0, s77, 1024
  s_add_u32 s79, s80, 4096
  buffer_load_dwordx4 v14, s[52:55], s79 offen nt lds
  s_waitcnt vmcnt(23)
  s_add_u32 m0, s77, 2048
  s_add_u32 s79, s80, 8192
  buffer_load_dwordx4 v15, s[52:55], s79 offen nt lds
  s_waitcnt vmcnt(23)
  s_add_u32 m0, s77, 3072
  s_add_u32 s79, s80, 12288
  buffer_load_dwordx4 v15, s[52:55], s79 offen nt lds
  s_waitcnt vmcnt(23)
  s_add_u32 m0, s77, 4096
  s_add_u32 s79, s80, 16384
  buffer_load_dwordx4 v14, s[52:55], s79 offen nt lds
  s_waitcnt vmcnt(23)
  s_add_u32 m0, s77, 5120
  s_add_u32 s79, s80, 20480
  buffer_load_dwordx4 v14, s[52:55], s79 offen nt lds
  s_waitcnt vmcnt(23)
  s_add_u32 m0, s77, 6144
  s_add_u32 s79, s80, 24576
  buffer_load_dwordx4 v15, s[52:55], s79 offen nt lds
  s_waitcnt vmcnt(23)
  s_add_u32 m0, s77, 7168
  s_add_u32 s79, s80, 28672
  buffer_load_dwordx4 v15, s[52:55], s79 offen nt lds
  s_waitcnt vmcnt(8)
  s_barrier
L_ldr:
  s_barrier
  s_waitcnt vmcnt(0)
  s_barrier
  s_endpgm
L_end:
  s_endpgm
L_code_end:
.section .rodata,"a"
.p2align 6
.amdhsa_kernel concat_heads__compressed_kv_cla__sliding_block_cached__decode_kernel
  .amdhsa_next_free_vgpr 256
  .amdhsa_next_free_sgpr 102
  .amdhsa_accum_offset 256
  .amdhsa_group_segment_fixed_size 0
  .amdhsa_kernarg_size 112
  .amdhsa_user_sgpr_count 2
  .amdhsa_user_sgpr_kernarg_segment_ptr 1
  .amdhsa_system_sgpr_workgroup_id_x 1
.end_amdhsa_kernel
```
